```python
import torch

def _softmax(x, axis=-1):
    return torch.softmax(x, dim=axis)
def _gelu(x):
    return torch.nn.functional.gelu(x, approximate="tanh")
def _silu(x):
    return torch.nn.functional.silu(x)
def _sigmoid(x):
    return torch.sigmoid(x)
def _layernorm(x, axis=-1, eps=1e-5):
    m = x.mean(dim=axis, keepdim=True)
    v = x.var(dim=axis, keepdim=True, unbiased=False)
    return (x - m) / torch.sqrt(v + eps)
def _scatter_add(tgt, idx, src, axis=0):
    return tgt.clone().index_add_(axis, idx, src)
def _segment_sum(src, seg, n):
    out = torch.zeros((n,) + src.shape[1:], dtype=src.dtype)
    return out.index_add_(0, seg, src)
def _pad(x, pw):
    flat = tuple(v for pair in reversed(pw) for v in pair)
    return torch.nn.functional.pad(x, flat)

kernel_name = 'concat_heads__mha_block_cached__mha_block_cached__decode'

def setup_inputs():

    _w = (lambda a: (lambda t: t.to(torch.bfloat16) if t.is_floating_point() else t)(torch.as_tensor(a)))
    def _A_setup():
        B, Sq, D = 2, 1, 512
        H, Sk, Dh = 32, 8192, 128
        return {
            "x": _w((lambda *s: torch.randn(*s, dtype=torch.bfloat16) * 0.8)(B, Sq, D)),
            "k_cache": _w((lambda *s: torch.randn(*s, dtype=torch.bfloat16) * 0.8)(B, H, Sk, Dh)),
            "v_cache": _w((lambda *s: torch.randn(*s, dtype=torch.bfloat16) * 0.05)(B, H, Sk, Dh)),
            "wq": _w((lambda *s: torch.randn(*s, dtype=torch.bfloat16) * 0.8)(D, H * Dh) * (D ** -0.5)),
            "wo": _w((lambda *s: torch.randn(*s, dtype=torch.bfloat16) * 0.05)(H * Dh, D) * ((H * Dh) ** -0.5)),
        }
    _A_in = _A_setup()

    def _B_setup():
        B, Sq, D = 2, 1, 512
        H, Sk, Dh = 32, 8192, 128
        return {
            "x": _w((lambda *s: torch.randn(*s, dtype=torch.bfloat16) * 0.8)(B, Sq, D)),
            "k_cache": _w((lambda *s: torch.randn(*s, dtype=torch.bfloat16) * 0.8)(B, H, Sk, Dh)),
            "v_cache": _w((lambda *s: torch.randn(*s, dtype=torch.bfloat16) * 0.05)(B, H, Sk, Dh)),
            "wq": _w((lambda *s: torch.randn(*s, dtype=torch.bfloat16) * 0.8)(D, H * Dh) * (D ** -0.5)),
            "wo": _w((lambda *s: torch.randn(*s, dtype=torch.bfloat16) * 0.05)(H * Dh, D) * ((H * Dh) ** -0.5)),
        }
    _B_in = _B_setup()

    return {
        "A_x": _A_in["x"],
        "A_k_cache": _A_in["k_cache"],
        "A_v_cache": _A_in["v_cache"],
        "A_wq": _A_in["wq"],
        "A_wo": _A_in["wo"],
        "B_x": _B_in["x"],
        "B_k_cache": _B_in["k_cache"],
        "B_v_cache": _B_in["v_cache"],
        "B_wq": _B_in["wq"],
        "B_wo": _B_in["wo"],
    }

def reference(A_x, A_k_cache, A_v_cache, A_wq, A_wo, B_x, B_k_cache, B_v_cache, B_wq, B_wo):
    def _A_ref(x, k_cache, v_cache, wq, wo):
        B, Sq, D = x.shape
        H, Dh = 32, 128
        q = (lambda x, *d: x.permute(*d))((x @ wq).reshape(B, Sq, H, Dh), 0, 2, 1, 3)
        scores = torch.einsum("bhqd,bhkd->bhqk", q, k_cache) * (Dh ** -0.5)
        p = _softmax(scores, axis=-1)
        o = torch.einsum("bhqk,bhkd->bhqd", p, v_cache)
        return (lambda x, *d: x.permute(*d))(o, 0, 2, 1, 3).reshape(B, Sq, H * Dh) @ wo

    def _B_ref(x, k_cache, v_cache, wq, wo):
        B, Sq, D = x.shape
        H, Dh = 32, 128
        q = (lambda x, *d: x.permute(*d))((x @ wq).reshape(B, Sq, H, Dh), 0, 2, 1, 3)
        scores = torch.einsum("bhqd,bhkd->bhqk", q, k_cache) * (Dh ** -0.5)
        p = _softmax(scores, axis=-1)
        o = torch.einsum("bhqk,bhkd->bhqd", p, v_cache)
        return (lambda x, *d: x.permute(*d))(o, 0, 2, 1, 3).reshape(B, Sq, H * Dh) @ wo

    a = _A_ref(A_x, A_k_cache, A_v_cache, A_wq, A_wo)
    b = _B_ref(B_x, B_k_cache, B_v_cache, B_wq, B_wo)
    return torch.concatenate([a, b], axis=-1)
```

```asm
; @launch kernel=concat_heads__mha_block_cached__mha_block_cached__decode_kernel grid=(256,1,1) block=(512,1,1) lds=148112
; @launch kernel=reduce_kernel grid=(64,1,1) block=(128,1,1) lds=0
.amdgcn_target "amdgcn-amd-amdhsa--gfx950"
.text
.globl concat_heads__mha_block_cached__mha_block_cached__decode_kernel
.p2align 8
.type concat_heads__mha_block_cached__mha_block_cached__decode_kernel,@function
concat_heads__mha_block_cached__mha_block_cached__decode_kernel:
    s_cmp_ge_u32 s2, 256
    s_cbranch_scc1 L_attn_end
    s_load_dwordx16 s[4:19], s[0:1], 0
    s_load_dwordx4 s[20:23], s[0:1], 64
    s_load_dwordx2 s[24:25], s[0:1], 96
    s_bfe_u32 s72, s2, 0x20006
    s_bfe_u32 s71, s2, 0x10005
    s_bfe_u32 s70, s2, 0x50000
    v_lshrrev_b32 v3, 6, v0
    v_and_b32 v1, 63, v0
    v_readfirstlane_b32 s3, v3
    v_lshrrev_b32 v3, 4, v0
    v_and_b32 v4, 15, v0
    v_lshlrev_b32 v4, 4, v4
    v_lshl_add_u32 v14, v3, 17, v4
    v_lshlrev_b32 v16, 5, v3
    v_lshlrev_b32 v2, 4, v1
    s_lshl_b32 s60, s3, 12
    v_add_u32 v2, s60, v2
    s_lshl_b32 s60, s71, 26
    s_lshl_b32 s61, s70, 21
    s_lshl_b32 s62, s72, 19
    s_add_u32 s60, s60, s61
    s_add_u32 s60, s60, s62
    s_lshl_b32 s61, s70, 8
    s_lshl_b32 s62, s71, 10
    s_lshl_b32 s63, s70, 17
    s_mov_b32 s30, 0x80000
    s_mov_b32 s31, 0x00020000
    s_mov_b32 s34, 0x3fe100
    s_mov_b32 s35, 0x00020000
    s_mov_b32 s42, 0x20000
    s_mov_b32 s43, 0x00020000
    s_mov_b32 s38, 0x400
    s_mov_b32 s39, 0x00020000
    s_mov_b32 s46, 0x120800
    s_mov_b32 s47, 0x00020000
    s_mov_b32 s74, 0
    s_lshl_b32 s75, s3, 14
    s_mov_b32 s69, 0
    s_waitcnt lgkmcnt(0)
    s_add_u32 s28, s6, s60
    s_addc_u32 s29, s7, 0
    s_add_u32 s36, s4, s62
    s_addc_u32 s37, s5, 0
    s_add_u32 s32, s10, s61
    s_addc_u32 s33, s11, 0
    buffer_load_dwordx4 v[92:95], v16, s[36:39], 0 offen
    buffer_load_dwordx4 v[96:99], v16, s[36:39], 0 offen offset:16
    buffer_load_dwordx4 v[100:103], v14, s[32:35], s74 offen nt
    s_add_u32 s74, s74, 0x2000
    buffer_load_dwordx4 v[104:107], v14, s[32:35], s74 offen nt
    s_add_u32 s74, s74, 0x2000
    s_add_u32 m0, s75, 0x2000
    s_nop 0
    buffer_load_dwordx4 v2, s[28:31], s69 offen offset:0 nt lds
    buffer_load_dwordx4 v[108:111], v14, s[32:35], s74 offen nt
    s_add_u32 s74, s74, 0x2000
    buffer_load_dwordx4 v[112:115], v14, s[32:35], s74 offen nt
    s_add_u32 s74, s74, 0x2000
    buffer_load_dwordx4 v2, s[28:31], s69 offen offset:1024 nt lds
    buffer_load_dwordx4 v[116:119], v14, s[32:35], s74 offen nt
    s_add_u32 s74, s74, 0x2000
    buffer_load_dwordx4 v[120:123], v14, s[32:35], s74 offen nt
    s_add_u32 s74, s74, 0x2000
    buffer_load_dwordx4 v2, s[28:31], s69 offen offset:2048 nt lds
    buffer_load_dwordx4 v[124:127], v14, s[32:35], s74 offen nt
    s_add_u32 s74, s74, 0x2000
    buffer_load_dwordx4 v[128:131], v14, s[32:35], s74 offen nt
    s_add_u32 s74, s74, 0x2000
    buffer_load_dwordx4 v2, s[28:31], s69 offen offset:3072 nt lds
    buffer_load_dwordx4 v[132:135], v14, s[32:35], s74 offen nt
    s_add_u32 s74, s74, 0x2000
    buffer_load_dwordx4 v[136:139], v14, s[32:35], s74 offen nt
    s_add_u32 s74, s74, 0x2000
    s_add_u32 s69, s69, 0x8000
    s_add_u32 m0, s75, 0x3000
    s_nop 0
    buffer_load_dwordx4 v2, s[28:31], s69 offen offset:0 nt lds
    buffer_load_dwordx4 v[140:143], v14, s[32:35], s74 offen nt
    s_add_u32 s74, s74, 0x2000
    buffer_load_dwordx4 v[144:147], v14, s[32:35], s74 offen nt
    s_add_u32 s74, s74, 0x2000
    buffer_load_dwordx4 v2, s[28:31], s69 offen offset:1024 nt lds
    buffer_load_dwordx4 v[148:151], v14, s[32:35], s74 offen nt
    s_add_u32 s74, s74, 0x2000
    buffer_load_dwordx4 v[152:155], v14, s[32:35], s74 offen nt
    s_add_u32 s74, s74, 0x2000
    buffer_load_dwordx4 v2, s[28:31], s69 offen offset:2048 nt lds
    buffer_load_dwordx4 v[156:159], v14, s[32:35], s74 offen nt
    s_add_u32 s74, s74, 0x2000
    buffer_load_dwordx4 v[160:163], v14, s[32:35], s74 offen nt
    buffer_load_dwordx4 v2, s[28:31], s69 offen offset:3072 nt lds
    s_add_u32 s69, s69, 0x8000
    s_cmp_eq_u32 s69, 0x80000
    s_cselect_b32 s28, s48, s28
    s_cselect_b32 s29, s49, s29
    s_cselect_b32 s30, s50, s30
    s_cselect_b32 s69, 0, s69
    buffer_load_dwordx4 v[164:167], v2, s[28:31], s69 offen offset:0 nt
    buffer_load_dwordx4 v[168:171], v2, s[28:31], s69 offen offset:1024 nt
    buffer_load_dwordx4 v[172:175], v2, s[28:31], s69 offen offset:2048 nt
    buffer_load_dwordx4 v[176:179], v2, s[28:31], s69 offen offset:3072 nt
    s_add_u32 s69, s69, 0x8000
    buffer_load_dwordx4 v[180:183], v2, s[28:31], s69 offen offset:0 nt
    buffer_load_dwordx4 v[184:187], v2, s[28:31], s69 offen offset:1024 nt
    buffer_load_dwordx4 v[188:191], v2, s[28:31], s69 offen offset:2048 nt
    buffer_load_dwordx4 v[192:195], v2, s[28:31], s69 offen offset:3072 nt
    s_add_u32 s48, s8, s60
    s_addc_u32 s49, s9, 0
    s_mov_b32 s50, 0x80000
    s_mov_b32 s51, 0x00020000
    s_add_u32 s54, s16, s60
    s_addc_u32 s55, s17, 0
    s_mov_b32 s56, 0x80000
    s_add_u32 s58, s18, s60
    s_addc_u32 s59, s19, 0
    s_add_u32 s40, s12, s63
    s_addc_u32 s41, s13, 0
    s_add_u32 s22, s22, s63
    s_addc_u32 s23, s23, 0
    s_add_u32 s36, s14, s62
    s_addc_u32 s37, s15, 0
    s_add_u32 s32, s20, s61
    s_addc_u32 s33, s21, 0
    s_mov_b32 s44, s24
    s_mov_b32 s45, s25
    s_mov_b32 s64, 0x3e0293ee
    s_mov_b32 s65, 0xffff0000
    s_mov_b32 s66, 0x05040100
    s_mov_b32 s67, 0x07060302
    s_mov_b32 s78, 0xcccccccc
    s_mov_b32 s79, 0xcccccccc
    s_mov_b32 s73, 0
    s_mov_b32 s27, 0
    s_and_b32 s60, s70, 7
    s_lshl_b32 s60, s60, 2
    s_lshr_b32 s26, 0x900060, s60
    s_and_b32 s26, s26, 15
    s_mov_b32 s74, 0
    v_add_u32 v15, 0x2000, v14
    v_lshrrev_b32 v3, 3, v1
    v_and_b32 v4, 7, v1
    v_and_b32 v5, 2, v3
    v_lshlrev_b32 v3, 10, v3
    v_xor_b32 v4, v4, v5
    v_lshl_add_u32 v3, v4, 4, v3
    s_lshl_b32 s60, s3, 7
    v_add_u32 v12, s60, v3
    v_xor_b32 v13, 64, v12
    v_lshrrev_b32 v3, 4, v1
    v_bfe_u32 v4, v1, 2, 2
    v_lshl_add_u32 v4, v3, 3, v4
    v_lshlrev_b32 v4, 7, v4
    v_bfe_u32 v5, v1, 3, 2
    v_lshl_add_u32 v4, v5, 5, v4
    v_and_b32 v5, 3, v1
    v_lshl_add_u32 v4, v5, 3, v4
    v_add_u32 v18, s75, v4
    v_xor_b32 v19, 32, v18
    v_xor_b32 v20, 64, v18
    v_xor_b32 v21, 96, v18
    v_and_b32 v4, 15, v1
    v_lshlrev_b32 v5, 5, v4
    v_lshl_add_u32 v5, v3, 3, v5
    v_add_u32 v23, 0x20000, v5
    s_lshl_b32 s60, s3, 9
    v_add_u32 v22, s60, v23
    v_lshlrev_b32 v5, 4, v4
    v_lshl_add_u32 v5, v3, 2, v5
    s_mul_i32 s60, s3, 272
    s_add_u32 s60, s60, 0x22000
    v_add_u32 v24, s60, v5
    v_mul_u32_u24 v5, 272, v4
    v_lshl_add_u32 v5, v3, 4, v5
    v_add_u32 v25, 0x22000, v5
    s_lshl_b32 s60, s3, 3
    s_add_u32 s60, s60, 0x24200
    v_mov_b32 v28, s60
    v_and_b32 v5, 1, v3
    v_lshlrev_b32 v5, 5, v5
    v_add_u32 v26, 0x24200, v5
    v_xor_b32 v27, 32, v26
    v_lshlrev_b32 v29, 2, v1
    v_lshlrev_b32 v37, 4, v1
    s_lshl_b32 s60, s71, 3
    s_add_u32 s60, s60, s3
    s_mul_i32 s60, s60, 32768
    s_lshl_b32 s61, s70, 2
    s_add_u32 s61, s61, s72
    s_lshl_b32 s77, s71, 7
    s_add_u32 s77, s77, s61
    s_lshl_b32 s77, s77, 7
    s_add_u32 s77, s77, 0x100000
    s_lshl_b32 s62, s61, 8
    s_add_u32 s76, s62, s60
    v_mov_b32 v52, 0
    v_mov_b32 v53, 0
    v_mov_b32 v54, 0
    v_mov_b32 v55, 0
    v_mov_b32 v56, 0
    v_mov_b32 v57, 0
    v_mov_b32 v58, 0
    v_mov_b32 v59, 0
    s_waitcnt vmcnt(30)
    v_perm_b32 v84, v104, v100, s66
    v_perm_b32 v85, v104, v100, s67
    v_perm_b32 v86, v105, v101, s66
    v_perm_b32 v87, v105, v101, s67
    v_perm_b32 v88, v106, v102, s66
    v_perm_b32 v89, v106, v102, s67
    v_perm_b32 v90, v107, v103, s66
    v_perm_b32 v91, v107, v103, s67
    v_dot2c_f32_bf16 v52, v84, v92
    v_dot2c_f32_bf16 v53, v85, v92
    v_dot2c_f32_bf16 v54, v86, v92
    v_dot2c_f32_bf16 v55, v87, v92
    v_dot2c_f32_bf16 v56, v88, v92
    v_dot2c_f32_bf16 v57, v89, v92
    v_dot2c_f32_bf16 v58, v90, v92
    v_dot2c_f32_bf16 v59, v91, v92
    s_waitcnt vmcnt(27)
    v_perm_b32 v84, v112, v108, s66
    v_perm_b32 v85, v112, v108, s67
    v_perm_b32 v86, v113, v109, s66
    v_perm_b32 v87, v113, v109, s67
    v_perm_b32 v88, v114, v110, s66
    v_perm_b32 v89, v114, v110, s67
    v_perm_b32 v90, v115, v111, s66
    v_perm_b32 v91, v115, v111, s67
    v_dot2c_f32_bf16 v52, v84, v93
    v_dot2c_f32_bf16 v53, v85, v93
    v_dot2c_f32_bf16 v54, v86, v93
    v_dot2c_f32_bf16 v55, v87, v93
    v_dot2c_f32_bf16 v56, v88, v93
    v_dot2c_f32_bf16 v57, v89, v93
    v_dot2c_f32_bf16 v58, v90, v93
    v_dot2c_f32_bf16 v59, v91, v93
    s_waitcnt vmcnt(24)
    v_perm_b32 v84, v120, v116, s66
    v_perm_b32 v85, v120, v116, s67
    v_perm_b32 v86, v121, v117, s66
    v_perm_b32 v87, v121, v117, s67
    v_perm_b32 v88, v122, v118, s66
    v_perm_b32 v89, v122, v118, s67
    v_perm_b32 v90, v123, v119, s66
    v_perm_b32 v91, v123, v119, s67
    v_dot2c_f32_bf16 v52, v84, v94
    v_dot2c_f32_bf16 v53, v85, v94
    v_dot2c_f32_bf16 v54, v86, v94
    v_dot2c_f32_bf16 v55, v87, v94
    v_dot2c_f32_bf16 v56, v88, v94
    v_dot2c_f32_bf16 v57, v89, v94
    v_dot2c_f32_bf16 v58, v90, v94
    v_dot2c_f32_bf16 v59, v91, v94
    s_waitcnt vmcnt(21)
    v_perm_b32 v84, v128, v124, s66
    v_perm_b32 v85, v128, v124, s67
    v_perm_b32 v86, v129, v125, s66
    v_perm_b32 v87, v129, v125, s67
    v_perm_b32 v88, v130, v126, s66
    v_perm_b32 v89, v130, v126, s67
    v_perm_b32 v90, v131, v127, s66
    v_perm_b32 v91, v131, v127, s67
    v_dot2c_f32_bf16 v52, v84, v95
    v_dot2c_f32_bf16 v53, v85, v95
    v_dot2c_f32_bf16 v54, v86, v95
    v_dot2c_f32_bf16 v55, v87, v95
    v_dot2c_f32_bf16 v56, v88, v95
    v_dot2c_f32_bf16 v57, v89, v95
    v_dot2c_f32_bf16 v58, v90, v95
    v_dot2c_f32_bf16 v59, v91, v95
    s_waitcnt vmcnt(18)
    v_perm_b32 v84, v136, v132, s66
    v_perm_b32 v85, v136, v132, s67
    v_perm_b32 v86, v137, v133, s66
    v_perm_b32 v87, v137, v133, s67
    v_perm_b32 v88, v138, v134, s66
    v_perm_b32 v89, v138, v134, s67
    v_perm_b32 v90, v139, v135, s66
    v_perm_b32 v91, v139, v135, s67
    v_dot2c_f32_bf16 v52, v84, v96
    v_dot2c_f32_bf16 v53, v85, v96
    v_dot2c_f32_bf16 v54, v86, v96
    v_dot2c_f32_bf16 v55, v87, v96
    v_dot2c_f32_bf16 v56, v88, v96
    v_dot2c_f32_bf16 v57, v89, v96
    v_dot2c_f32_bf16 v58, v90, v96
    v_dot2c_f32_bf16 v59, v91, v96
    s_waitcnt vmcnt(15)
    v_perm_b32 v84, v144, v140, s66
    v_perm_b32 v85, v144, v140, s67
    v_perm_b32 v86, v145, v141, s66
    v_perm_b32 v87, v145, v141, s67
    v_perm_b32 v88, v146, v142, s66
    v_perm_b32 v89, v146, v142, s67
    v_perm_b32 v90, v147, v143, s66
    v_perm_b32 v91, v147, v143, s67
    v_dot2c_f32_bf16 v52, v84, v97
    v_dot2c_f32_bf16 v53, v85, v97
    v_dot2c_f32_bf16 v54, v86, v97
    v_dot2c_f32_bf16 v55, v87, v97
    v_dot2c_f32_bf16 v56, v88, v97
    v_dot2c_f32_bf16 v57, v89, v97
    v_dot2c_f32_bf16 v58, v90, v97
    v_dot2c_f32_bf16 v59, v91, v97
    s_waitcnt vmcnt(12)
    v_perm_b32 v84, v152, v148, s66
    v_perm_b32 v85, v152, v148, s67
    v_perm_b32 v86, v153, v149, s66
    v_perm_b32 v87, v153, v149, s67
    v_perm_b32 v88, v154, v150, s66
    v_perm_b32 v89, v154, v150, s67
    v_perm_b32 v90, v155, v151, s66
    v_perm_b32 v91, v155, v151, s67
    v_dot2c_f32_bf16 v52, v84, v98
    v_dot2c_f32_bf16 v53, v85, v98
    v_dot2c_f32_bf16 v54, v86, v98
    v_dot2c_f32_bf16 v55, v87, v98
    v_dot2c_f32_bf16 v56, v88, v98
    v_dot2c_f32_bf16 v57, v89, v98
    v_dot2c_f32_bf16 v58, v90, v98
    v_dot2c_f32_bf16 v59, v91, v98
    s_waitcnt vmcnt(9)
    v_perm_b32 v84, v160, v156, s66
    v_perm_b32 v85, v160, v156, s67
    v_perm_b32 v86, v161, v157, s66
    v_perm_b32 v87, v161, v157, s67
    v_perm_b32 v88, v162, v158, s66
    v_perm_b32 v89, v162, v158, s67
    v_perm_b32 v90, v163, v159, s66
    v_perm_b32 v91, v163, v159, s67
    v_dot2c_f32_bf16 v52, v84, v99
    v_dot2c_f32_bf16 v53, v85, v99
    v_dot2c_f32_bf16 v54, v86, v99
    v_dot2c_f32_bf16 v55, v87, v99
    v_dot2c_f32_bf16 v56, v88, v99
    v_dot2c_f32_bf16 v57, v89, v99
    v_dot2c_f32_bf16 v58, v90, v99
    v_dot2c_f32_bf16 v59, v91, v99
    v_permlane32_swap_b32 v52, v56
    s_nop 0
    v_permlane32_swap_b32 v54, v58
    v_permlane32_swap_b32 v53, v57
    v_permlane32_swap_b32 v55, v59
    v_add_f32 v52, v52, v56
    v_add_f32 v54, v54, v58
    v_add_f32 v53, v53, v57
    v_add_f32 v55, v55, v59
    v_permlane16_swap_b32 v52, v54
    s_nop 0
    v_permlane16_swap_b32 v53, v55
    v_add_f32 v84, v52, v54
    v_add_f32 v85, v53, v55
    ds_write_b64 v22, v[84:85]
    s_waitcnt lgkmcnt(0)
    s_barrier
    ds_read_b64 v[60:61], v23 offset:0
    ds_read_b64 v[62:63], v23 offset:512
    ds_read_b64 v[64:65], v23 offset:1024
    ds_read_b64 v[66:67], v23 offset:1536
    ds_read_b64 v[68:69], v23 offset:2048
    ds_read_b64 v[70:71], v23 offset:2560
    ds_read_b64 v[72:73], v23 offset:3072
    ds_read_b64 v[74:75], v23 offset:3584
    v_add_u32 v22, 0x1000, v22
    v_add_u32 v23, 0x1000, v23
    s_waitcnt lgkmcnt(0)
    v_add_f32 v60, v60, v62
    v_add_f32 v61, v61, v63
    v_add_f32 v60, v60, v64
    v_add_f32 v61, v61, v65
    v_add_f32 v60, v60, v66
    v_add_f32 v61, v61, v67
    v_add_f32 v60, v60, v68
    v_add_f32 v61, v61, v69
    v_add_f32 v60, v60, v70
    v_add_f32 v61, v61, v71
    v_add_f32 v60, v60, v72
    v_add_f32 v61, v61, v73
    v_add_f32 v60, v60, v74
    v_add_f32 v61, v61, v75
    v_cvt_pk_bf16_f32 v40, v60, v61
    v_mov_b32 v41, v40
    s_nop 1
    v_permlane16_swap_b32 v40, v41
    v_mov_b32 v42, v40
    v_mov_b32 v43, v41
    s_nop 0
    v_permlane32_swap_b32 v40, v42
    v_permlane32_swap_b32 v41, v43
    s_mov_b32 s68, 0
    s_waitcnt vmcnt(8)
    v_add_u32 v3, s75, v37
    ds_read_b128 v[100:103], v3 offset:8192
    ds_read_b128 v[104:107], v3 offset:9216
    ds_read_b128 v[108:111], v3 offset:10240
    ds_read_b128 v[112:115], v3 offset:11264
    ds_read_b128 v[116:119], v3 offset:12288
    ds_read_b128 v[120:123], v3 offset:13312
    ds_read_b128 v[124:127], v3 offset:14336
    ds_read_b128 v[128:131], v3 offset:15360
    s_waitcnt lgkmcnt(7)
    v_dot2_f32_bf16 v60, v100, v40, 0
    v_dot2_f32_bf16 v60, v101, v41, v60
    v_dot2_f32_bf16 v60, v102, v42, v60
    v_dot2_f32_bf16 v60, v103, v43, v60
    s_waitcnt lgkmcnt(6)
    v_dot2_f32_bf16 v61, v104, v40, 0
    v_dot2_f32_bf16 v61, v105, v41, v61
    v_dot2_f32_bf16 v61, v106, v42, v61
    v_dot2_f32_bf16 v61, v107, v43, v61
    s_mov_b32 m0, s75
    s_add_u32 s75, s75, 0x400
    buffer_load_dwordx4 v12, s[40:43], s74 offen nt lds
    s_add_u32 s74, s74, 0x2000
    s_waitcnt lgkmcnt(5)
    v_dot2_f32_bf16 v62, v108, v40, 0
    v_dot2_f32_bf16 v62, v109, v41, v62
    v_dot2_f32_bf16 v62, v110, v42, v62
    v_dot2_f32_bf16 v62, v111, v43, v62
    v_add_f32_dpp v60, v60, v60 row_ror:8 row_mask:0xf bank_mask:0x3
    v_add_f32_dpp v60, v61, v61 row_ror:8 row_mask:0xf bank_mask:0xc
    s_waitcnt lgkmcnt(4)
    v_dot2_f32_bf16 v63, v112, v40, 0
    v_dot2_f32_bf16 v63, v113, v41, v63
    v_dot2_f32_bf16 v63, v114, v42, v63
    v_dot2_f32_bf16 v63, v115, v43, v63
    s_waitcnt lgkmcnt(3)
    v_dot2_f32_bf16 v64, v116, v40, 0
    v_dot2_f32_bf16 v64, v117, v41, v64
    v_dot2_f32_bf16 v64, v118, v42, v64
    v_dot2_f32_bf16 v64, v119, v43, v64
    v_add_f32_dpp v62, v62, v62 row_ror:8 row_mask:0xf bank_mask:0x3
    v_add_f32_dpp v62, v63, v63 row_ror:8 row_mask:0xf bank_mask:0xc
    s_waitcnt lgkmcnt(2)
    v_dot2_f32_bf16 v65, v120, v40, 0
    v_dot2_f32_bf16 v65, v121, v41, v65
    v_dot2_f32_bf16 v65, v122, v42, v65
    v_dot2_f32_bf16 v65, v123, v43, v65
    s_mov_b32 m0, s75
    s_add_u32 s75, s75, 0x400
    buffer_load_dwordx4 v13, s[40:43], s74 offen nt lds
    s_add_u32 s74, s74, 0x2000
    v_add_f32_dpp v60, v60, v60 row_shl:4 row_mask:0xf bank_mask:0x5
    v_add_f32_dpp v60, v62, v62 row_shr:4 row_mask:0xf bank_mask:0xa
    s_waitcnt lgkmcnt(1)
    v_dot2_f32_bf16 v66, v124, v40, 0
    v_dot2_f32_bf16 v66, v125, v41, v66
    v_dot2_f32_bf16 v66, v126, v42, v66
    v_dot2_f32_bf16 v66, v127, v43, v66
    v_add_f32_dpp v64, v64, v64 row_ror:8 row_mask:0xf bank_mask:0x3
    v_add_f32_dpp v64, v65, v65 row_ror:8 row_mask:0xf bank_mask:0xc
    v_add_f32_dpp v60, v60, v60 quad_perm:[2,3,0,1] row_mask:0xf bank_mask:0xf
    s_waitcnt lgkmcnt(0)
    v_dot2_f32_bf16 v67, v128, v40, 0
    v_dot2_f32_bf16 v67, v129, v41, v67
    v_dot2_f32_bf16 v67, v130, v42, v67
    v_dot2_f32_bf16 v67, v131, v43, v67
    v_mov_b32 v83, v82
    v_mov_b32 v82, v81
    v_mov_b32 v81, v80
    v_add_f32_dpp v66, v66, v66 row_ror:8 row_mask:0xf bank_mask:0x3
    v_add_f32_dpp v66, v67, v67 row_ror:8 row_mask:0xf bank_mask:0xc
    v_add_f32_dpp v64, v64, v64 row_shl:4 row_mask:0xf bank_mask:0x5
    v_mov_b32 v80, v79
    v_add_f32_dpp v64, v66, v66 row_shr:4 row_mask:0xf bank_mask:0xa
    v_mov_b32 v79, v78
    v_mov_b32 v78, v77
    v_add_f32_dpp v64, v64, v64 quad_perm:[2,3,0,1] row_mask:0xf bank_mask:0xf
    v_mov_b32 v77, v76
    v_cndmask_b32 v60, v60, v64, s[78:79]
    s_add_u32 s68, s68, 1
    s_cmp_lt_u32 s68, 8
    v_add_f32_dpp v76, v60, v60 quad_perm:[1,0,3,2] row_mask:0xf bank_mask:0xf
L_prob:
    s_waitcnt vmcnt(7)
    v_dot2_f32_bf16 v60, v164, v40, 0
    v_dot2_f32_bf16 v60, v165, v41, v60
    v_dot2_f32_bf16 v60, v166, v42, v60
    v_dot2_f32_bf16 v60, v167, v43, v60
    s_waitcnt vmcnt(6)
    v_dot2_f32_bf16 v61, v168, v40, 0
    v_dot2_f32_bf16 v61, v169, v41, v61
    v_dot2_f32_bf16 v61, v170, v42, v61
    v_dot2_f32_bf16 v61, v171, v43, v61
    s_mov_b32 m0, s75
    s_add_u32 s75, s75, 0x400
    buffer_load_dwordx4 v12, s[40:43], s74 offen nt lds
    s_add_u32 s74, s74, 0x2000
    s_waitcnt vmcnt(6)
    v_dot2_f32_bf16 v62, v172, v40, 0
    v_dot2_f32_bf16 v62, v173, v41, v62
    v_dot2_f32_bf16 v62, v174, v42, v62
    v_dot2_f32_bf16 v62, v175, v43, v62
    v_add_f32_dpp v60, v60, v60 row_ror:8 row_mask:0xf bank_mask:0x3
    v_add_f32_dpp v60, v61, v61 row_ror:8 row_mask:0xf bank_mask:0xc
    s_waitcnt vmcnt(5)
    v_dot2_f32_bf16 v63, v176, v40, 0
    v_dot2_f32_bf16 v63, v177, v41, v63
    v_dot2_f32_bf16 v63, v178, v42, v63
    v_dot2_f32_bf16 v63, v179, v43, v63
    s_waitcnt vmcnt(4)
    s_add_u32 s69, s69, 0x8000
    s_cmp_eq_u32 s69, 0x80000
    s_cselect_b32 s28, s48, s28
    s_cselect_b32 s29, s49, s29
    s_cselect_b32 s30, s50, s30
    s_cselect_b32 s69, 0, s69
    buffer_load_dwordx4 v[164:167], v2, s[28:31], s69 offen offset:0 nt
    v_dot2_f32_bf16 v64, v180, v40, 0
    v_dot2_f32_bf16 v64, v181, v41, v64
    v_dot2_f32_bf16 v64, v182, v42, v64
    v_dot2_f32_bf16 v64, v183, v43, v64
    v_add_f32_dpp v62, v62, v62 row_ror:8 row_mask:0xf bank_mask:0x3
    v_add_f32_dpp v62, v63, v63 row_ror:8 row_mask:0xf bank_mask:0xc
    s_waitcnt vmcnt(4)
    buffer_load_dwordx4 v[168:171], v2, s[28:31], s69 offen offset:1024 nt
    v_dot2_f32_bf16 v65, v184, v40, 0
    v_dot2_f32_bf16 v65, v185, v41, v65
    v_dot2_f32_bf16 v65, v186, v42, v65
    v_dot2_f32_bf16 v65, v187, v43, v65
    s_mov_b32 m0, s75
    s_add_u32 s75, s75, 0x400
    buffer_load_dwordx4 v13, s[40:43], s74 offen nt lds
    s_add_u32 s74, s74, 0x2000
    v_add_f32_dpp v60, v60, v60 row_shl:4 row_mask:0xf bank_mask:0x5
    v_add_f32_dpp v60, v62, v62 row_shr:4 row_mask:0xf bank_mask:0xa
    s_waitcnt vmcnt(5)
    v_dot2_f32_bf16 v66, v188, v40, 0
    v_dot2_f32_bf16 v66, v189, v41, v66
    v_dot2_f32_bf16 v66, v190, v42, v66
    v_dot2_f32_bf16 v66, v191, v43, v66
    v_add_f32_dpp v64, v64, v64 row_ror:8 row_mask:0xf bank_mask:0x3
    v_add_f32_dpp v64, v65, v65 row_ror:8 row_mask:0xf bank_mask:0xc
    v_add_f32_dpp v60, v60, v60 quad_perm:[2,3,0,1] row_mask:0xf bank_mask:0xf
    s_waitcnt vmcnt(4)
    v_dot2_f32_bf16 v67, v192, v40, 0
    v_dot2_f32_bf16 v67, v193, v41, v67
    v_dot2_f32_bf16 v67, v194, v42, v67
    v_dot2_f32_bf16 v67, v195, v43, v67
    v_mov_b32 v83, v82
    v_mov_b32 v82, v81
    v_mov_b32 v81, v80
    v_add_f32_dpp v66, v66, v66 row_ror:8 row_mask:0xf bank_mask:0x3
    v_add_f32_dpp v66, v67, v67 row_ror:8 row_mask:0xf bank_mask:0xc
    v_add_f32_dpp v64, v64, v64 row_shl:4 row_mask:0xf bank_mask:0x5
    v_mov_b32 v80, v79
    v_add_f32_dpp v64, v66, v66 row_shr:4 row_mask:0xf bank_mask:0xa
    v_mov_b32 v79, v78
    v_mov_b32 v78, v77
    v_add_f32_dpp v64, v64, v64 quad_perm:[2,3,0,1] row_mask:0xf bank_mask:0xf
    v_mov_b32 v77, v76
    v_cndmask_b32 v60, v60, v64, s[78:79]
    s_add_u32 s68, s68, 1
    s_cmp_lt_u32 s68, 8
    v_add_f32_dpp v76, v60, v60 quad_perm:[1,0,3,2] row_mask:0xf bank_mask:0xf
L_ks:
    s_cmp_eq_u32 s26, 0
    s_cbranch_scc1 L_ksl
    s_sub_u32 s26, s26, 1
    s_waitcnt vmcnt(2)
    buffer_load_dwordx4 v[172:175], v2, s[28:31], s69 offen offset:2048 nt
    buffer_load_dwordx4 v[176:179], v2, s[28:31], s69 offen offset:3072 nt
    s_add_u32 s69, s69, 0x8000
    buffer_load_dwordx4 v[180:183], v2, s[28:31], s69 offen offset:0 nt
    v_dot2_f32_bf16 v60, v164, v40, 0
    v_dot2_f32_bf16 v60, v165, v41, v60
    v_dot2_f32_bf16 v60, v166, v42, v60
    v_dot2_f32_bf16 v60, v167, v43, v60
    s_waitcnt vmcnt(3)
    buffer_load_dwordx4 v[184:187], v2, s[28:31], s69 offen offset:1024 nt
    v_dot2_f32_bf16 v61, v168, v40, 0
    v_dot2_f32_bf16 v61, v169, v41, v61
    v_dot2_f32_bf16 v61, v170, v42, v61
    v_dot2_f32_bf16 v61, v171, v43, v61
    s_mov_b32 m0, s75
    s_add_u32 s75, s75, 0x400
    buffer_load_dwordx4 v12, s[40:43], s74 offen nt lds
    s_add_u32 s74, s74, 0x2000
    s_waitcnt vmcnt(4)
    buffer_load_dwordx4 v[188:191], v2, s[28:31], s69 offen offset:2048 nt
    v_dot2_f32_bf16 v62, v172, v40, 0
    v_dot2_f32_bf16 v62, v173, v41, v62
    v_dot2_f32_bf16 v62, v174, v42, v62
    v_dot2_f32_bf16 v62, v175, v43, v62
    v_add_f32_dpp v60, v60, v60 row_ror:8 row_mask:0xf bank_mask:0x3
    v_add_f32_dpp v60, v61, v61 row_ror:8 row_mask:0xf bank_mask:0xc
    s_waitcnt vmcnt(4)
    buffer_load_dwordx4 v[192:195], v2, s[28:31], s69 offen offset:3072 nt
    v_dot2_f32_bf16 v63, v176, v40, 0
    v_dot2_f32_bf16 v63, v177, v41, v63
    v_dot2_f32_bf16 v63, v178, v42, v63
    v_dot2_f32_bf16 v63, v179, v43, v63
    s_waitcnt vmcnt(4)
    s_add_u32 s69, s69, 0x8000
    s_cmp_eq_u32 s69, 0x80000
    s_cselect_b32 s28, s48, s28
    s_cselect_b32 s29, s49, s29
    s_cselect_b32 s30, s50, s30
    s_cselect_b32 s69, 0, s69
    buffer_load_dwordx4 v[164:167], v2, s[28:31], s69 offen offset:0 nt
    v_dot2_f32_bf16 v64, v180, v40, 0
    v_dot2_f32_bf16 v64, v181, v41, v64
    v_dot2_f32_bf16 v64, v182, v42, v64
    v_dot2_f32_bf16 v64, v183, v43, v64
    v_add_f32_dpp v62, v62, v62 row_ror:8 row_mask:0xf bank_mask:0x3
    v_add_f32_dpp v62, v63, v63 row_ror:8 row_mask:0xf bank_mask:0xc
    s_waitcnt vmcnt(4)
    buffer_load_dwordx4 v[168:171], v2, s[28:31], s69 offen offset:1024 nt
    v_dot2_f32_bf16 v65, v184, v40, 0
    v_dot2_f32_bf16 v65, v185, v41, v65
    v_dot2_f32_bf16 v65, v186, v42, v65
    v_dot2_f32_bf16 v65, v187, v43, v65
    s_mov_b32 m0, s75
    s_add_u32 s75, s75, 0x400
    buffer_load_dwordx4 v13, s[40:43], s74 offen nt lds
    s_add_u32 s74, s74, 0x2000
    v_add_f32_dpp v60, v60, v60 row_shl:4 row_mask:0xf bank_mask:0x5
    v_add_f32_dpp v60, v62, v62 row_shr:4 row_mask:0xf bank_mask:0xa
    s_waitcnt vmcnt(4)
    v_dot2_f32_bf16 v66, v188, v40, 0
    v_dot2_f32_bf16 v66, v189, v41, v66
    v_dot2_f32_bf16 v66, v190, v42, v66
    v_dot2_f32_bf16 v66, v191, v43, v66
    v_add_f32_dpp v64, v64, v64 row_ror:8 row_mask:0xf bank_mask:0x3
    v_add_f32_dpp v64, v65, v65 row_ror:8 row_mask:0xf bank_mask:0xc
    v_add_f32_dpp v60, v60, v60 quad_perm:[2,3,0,1] row_mask:0xf bank_mask:0xf
    s_waitcnt vmcnt(3)
    v_dot2_f32_bf16 v67, v192, v40, 0
    v_dot2_f32_bf16 v67, v193, v41, v67
    v_dot2_f32_bf16 v67, v194, v42, v67
    v_dot2_f32_bf16 v67, v195, v43, v67
    v_mov_b32 v83, v82
    v_mov_b32 v82, v81
    v_mov_b32 v81, v80
    v_add_f32_dpp v66, v66, v66 row_ror:8 row_mask:0xf bank_mask:0x3
    v_add_f32_dpp v66, v67, v67 row_ror:8 row_mask:0xf bank_mask:0xc
    v_add_f32_dpp v64, v64, v64 row_shl:4 row_mask:0xf bank_mask:0x5
    v_mov_b32 v80, v79
    v_add_f32_dpp v64, v66, v66 row_shr:4 row_mask:0xf bank_mask:0xa
    v_mov_b32 v79, v78
    v_mov_b32 v78, v77
    v_add_f32_dpp v64, v64, v64 quad_perm:[2,3,0,1] row_mask:0xf bank_mask:0xf
    v_mov_b32 v77, v76
    v_cndmask_b32 v60, v60, v64, s[78:79]
    s_add_u32 s68, s68, 1
    s_cmp_lt_u32 s68, 8
    v_add_f32_dpp v76, v60, v60 quad_perm:[1,0,3,2] row_mask:0xf bank_mask:0xf
    s_cbranch_scc1 L_ks
    s_branch L_kv
L_ksl:
    s_waitcnt vmcnt(2)
    buffer_load_dwordx4 v[172:175], v2, s[28:31], s69 offen offset:2048 nt
    buffer_load_dwordx4 v[176:179], v2, s[28:31], s69 offen offset:3072 nt
    v_dot2_f32_bf16 v60, v164, v40, 0
    v_dot2_f32_bf16 v60, v165, v41, v60
    v_dot2_f32_bf16 v60, v166, v42, v60
    v_dot2_f32_bf16 v60, v167, v43, v60
    s_waitcnt vmcnt(2)
    s_add_u32 s69, s69, 0x8000
    buffer_load_dwordx4 v[180:183], v2, s[28:31], s69 offen offset:0 nt
    v_dot2_f32_bf16 v61, v168, v40, 0
    v_dot2_f32_bf16 v61, v169, v41, v61
    v_dot2_f32_bf16 v61, v170, v42, v61
    v_dot2_f32_bf16 v61, v171, v43, v61
    s_mov_b32 m0, s75
    s_add_u32 s75, s75, 0x400
    buffer_load_dwordx4 v12, s[40:43], s74 offen nt lds
    s_add_u32 s74, s74, 0x2000
    s_waitcnt vmcnt(3)
    buffer_load_dwordx4 v[184:187], v2, s[28:31], s69 offen offset:1024 nt
    v_dot2_f32_bf16 v62, v172, v40, 0
    v_dot2_f32_bf16 v62, v173, v41, v62
    v_dot2_f32_bf16 v62, v174, v42, v62
    v_dot2_f32_bf16 v62, v175, v43, v62
    v_add_f32_dpp v60, v60, v60 row_ror:8 row_mask:0xf bank_mask:0x3
    v_add_f32_dpp v60, v61, v61 row_ror:8 row_mask:0xf bank_mask:0xc
    s_waitcnt vmcnt(3)
    v_dot2_f32_bf16 v63, v176, v40, 0
    v_dot2_f32_bf16 v63, v177, v41, v63
    v_dot2_f32_bf16 v63, v178, v42, v63
    v_dot2_f32_bf16 v63, v179, v43, v63
    s_waitcnt vmcnt(2)
    buffer_load_dwordx4 v[188:191], v2, s[28:31], s69 offen offset:2048 nt
    buffer_load_dwordx4 v[192:195], v2, s[28:31], s69 offen offset:3072 nt
    v_dot2_f32_bf16 v64, v180, v40, 0
    v_dot2_f32_bf16 v64, v181, v41, v64
    v_dot2_f32_bf16 v64, v182, v42, v64
    v_dot2_f32_bf16 v64, v183, v43, v64
    v_add_f32_dpp v62, v62, v62 row_ror:8 row_mask:0xf bank_mask:0x3
    v_add_f32_dpp v62, v63, v63 row_ror:8 row_mask:0xf bank_mask:0xc
    s_waitcnt vmcnt(2)
    s_add_u32 s69, s69, 0x8000
    s_cmp_eq_u32 s69, 0x80000
    s_cselect_b32 s28, s48, s28
    s_cselect_b32 s29, s49, s29
    s_cselect_b32 s30, s50, s30
    s_cselect_b32 s69, 0, s69
    buffer_load_dwordx4 v[164:167], v2, s[28:31], s69 offen offset:0 nt
    v_dot2_f32_bf16 v65, v184, v40, 0
    v_dot2_f32_bf16 v65, v185, v41, v65
    v_dot2_f32_bf16 v65, v186, v42, v65
    v_dot2_f32_bf16 v65, v187, v43, v65
    s_mov_b32 m0, s75
    s_add_u32 s75, s75, 0x400
    buffer_load_dwordx4 v13, s[40:43], s74 offen nt lds
    s_add_u32 s74, s74, 0x2000
    v_add_f32_dpp v60, v60, v60 row_shl:4 row_mask:0xf bank_mask:0x5
    v_add_f32_dpp v60, v62, v62 row_shr:4 row_mask:0xf bank_mask:0xa
    s_waitcnt vmcnt(3)
    buffer_load_dwordx4 v[168:171], v2, s[28:31], s69 offen offset:1024 nt
    v_dot2_f32_bf16 v66, v188, v40, 0
    v_dot2_f32_bf16 v66, v189, v41, v66
    v_dot2_f32_bf16 v66, v190, v42, v66
    v_dot2_f32_bf16 v66, v191, v43, v66
    v_add_f32_dpp v64, v64, v64 row_ror:8 row_mask:0xf bank_mask:0x3
    v_add_f32_dpp v64, v65, v65 row_ror:8 row_mask:0xf bank_mask:0xc
    v_add_f32_dpp v60, v60, v60 quad_perm:[2,3,0,1] row_mask:0xf bank_mask:0xf
    s_waitcnt vmcnt(3)
    v_dot2_f32_bf16 v67, v192, v40, 0
    v_dot2_f32_bf16 v67, v193, v41, v67
    v_dot2_f32_bf16 v67, v194, v42, v67
    v_dot2_f32_bf16 v67, v195, v43, v67
    v_mov_b32 v83, v82
    v_mov_b32 v82, v81
    v_mov_b32 v81, v80
    v_add_f32_dpp v66, v66, v66 row_ror:8 row_mask:0xf bank_mask:0x3
    v_add_f32_dpp v66, v67, v67 row_ror:8 row_mask:0xf bank_mask:0xc
    v_add_f32_dpp v64, v64, v64 row_shl:4 row_mask:0xf bank_mask:0x5
    v_mov_b32 v80, v79
    v_add_f32_dpp v64, v66, v66 row_shr:4 row_mask:0xf bank_mask:0xa
    v_mov_b32 v79, v78
    v_mov_b32 v78, v77
    v_add_f32_dpp v64, v64, v64 quad_perm:[2,3,0,1] row_mask:0xf bank_mask:0xf
    v_mov_b32 v77, v76
    v_cndmask_b32 v60, v60, v64, s[78:79]
    s_add_u32 s68, s68, 1
    s_cmp_lt_u32 s68, 8
    v_add_f32_dpp v76, v60, v60 quad_perm:[1,0,3,2] row_mask:0xf bank_mask:0xf
    s_cbranch_scc1 L_ks
L_kv:
    v_max3_f32 v10, v76, v77, v78
    v_max3_f32 v3, v79, v80, v81
    v_max3_f32 v10, v82, v83, v10
    v_max_f32 v10, v10, v3
    buffer_load_dwordx4 v[92:95], v14, s[32:35], 0 offen nt
    buffer_load_dwordx4 v[96:99], v15, s[32:35], 0 offen nt
    buffer_load_dword v17, v16, s[36:39], 0 offen
    v_add_u32 v14, 0x4000, v14
    v_add_u32 v15, 0x4000, v15
    v_add_u32 v16, 4, v16
    v_max_f32_dpp v10, v10, v10 row_ror:8 row_mask:0xf bank_mask:0xf
    s_nop 1
    v_max_f32_dpp v10, v10, v10 row_ror:4 row_mask:0xf bank_mask:0xf
    s_nop 1
    v_max_f32_dpp v10, v10, v10 row_ror:2 row_mask:0xf bank_mask:0xf
    v_mov_b32 v3, v10
    s_nop 1
    v_permlane32_swap_b32 v10, v3
    v_max_f32 v10, v10, v3
    v_mov_b32 v3, v10
    s_nop 1
    v_permlane16_swap_b32 v10, v3
    v_max_f32 v10, v10, v3
    v_mul_f32 v10, s64, v10
    v_fma_f32 v76, v76, s64, -v10
    v_fma_f32 v77, v77, s64, -v10
    v_fma_f32 v78, v78, s64, -v10
    v_fma_f32 v79, v79, s64, -v10
    v_fma_f32 v80, v80, s64, -v10
    v_fma_f32 v81, v81, s64, -v10
    v_fma_f32 v82, v82, s64, -v10
    v_fma_f32 v83, v83, s64, -v10
    v_exp_f32 v76, v76
    v_exp_f32 v77, v77
    v_exp_f32 v78, v78
    v_exp_f32 v79, v79
    v_exp_f32 v80, v80
    v_exp_f32 v81, v81
    v_exp_f32 v82, v82
    v_exp_f32 v83, v83
    v_mov_b32 v44, 0
    v_mov_b32 v45, 0
    v_mov_b32 v46, 0
    v_mov_b32 v47, 0
    v_mov_b32 v48, 0
    v_mov_b32 v49, 0
    v_mov_b32 v50, 0
    v_mov_b32 v51, 0
    v_mov_b32 v52, 0
    v_mov_b32 v53, 0
    v_mov_b32 v54, 0
    v_mov_b32 v55, 0
    v_mov_b32 v56, 0
    v_mov_b32 v57, 0
    v_mov_b32 v58, 0
    v_mov_b32 v59, 0
    v_add_f32 v11, v76, v77
    v_add_f32 v11, v11, v78
    v_add_f32 v11, v11, v79
    v_add_f32 v11, v11, v80
    v_add_f32 v11, v11, v81
    v_add_f32 v11, v11, v82
    v_add_f32 v11, v11, v83
    s_nop 1
    v_add_f32_dpp v11, v11, v11 row_ror:8 row_mask:0xf bank_mask:0xf
    s_nop 1
    v_add_f32_dpp v11, v11, v11 row_ror:4 row_mask:0xf bank_mask:0xf
    s_nop 1
    v_add_f32_dpp v11, v11, v11 row_ror:2 row_mask:0xf bank_mask:0xf
    v_mov_b32 v3, v11
    s_nop 1
    v_permlane32_swap_b32 v11, v3
    v_add_f32 v11, v11, v3
    v_mov_b32 v3, v11
    s_nop 1
    v_permlane16_swap_b32 v11, v3
    v_add_f32 v11, v11, v3
    s_mov_b64 exec, 1
    ds_write_b64 v28, v[10:11]
    s_mov_b64 exec, -1
    s_waitcnt vmcnt(3)
    ds_read_b64_tr_b16 v[100:101], v18 offset:0
    ds_read_b64_tr_b16 v[102:103], v18 offset:512
    ds_read_b64_tr_b16 v[104:105], v19 offset:0
    ds_read_b64_tr_b16 v[106:107], v19 offset:512
    ds_read_b64_tr_b16 v[108:109], v20 offset:0
    ds_read_b64_tr_b16 v[110:111], v20 offset:512
    ds_read_b64_tr_b16 v[112:113], v21 offset:0
    ds_read_b64_tr_b16 v[114:115], v21 offset:512
    ds_read_b64_tr_b16 v[116:117], v18 offset:4096
    ds_read_b64_tr_b16 v[118:119], v18 offset:4608
    ds_read_b64_tr_b16 v[120:121], v19 offset:4096
    ds_read_b64_tr_b16 v[122:123], v19 offset:4608
    ds_read_b64_tr_b16 v[124:125], v20 offset:4096
    ds_read_b64_tr_b16 v[126:127], v20 offset:4608
    ds_read_b64_tr_b16 v[128:129], v21 offset:4096
    ds_read_b64_tr_b16 v[130:131], v21 offset:4608
    ds_read_b64_tr_b16 v[132:133], v18 offset:8192
    ds_read_b64_tr_b16 v[134:135], v18 offset:8704
    ds_read_b64_tr_b16 v[136:137], v19 offset:8192
    ds_read_b64_tr_b16 v[138:139], v19 offset:8704
    ds_read_b64_tr_b16 v[140:141], v20 offset:8192
    ds_read_b64_tr_b16 v[142:143], v20 offset:8704
    ds_read_b64_tr_b16 v[144:145], v21 offset:8192
    ds_read_b64_tr_b16 v[146:147], v21 offset:8704
    ds_read_b64_tr_b16 v[148:149], v18 offset:12288
    ds_read_b64_tr_b16 v[150:151], v18 offset:12800
    ds_read_b64_tr_b16 v[152:153], v19 offset:12288
    ds_read_b64_tr_b16 v[154:155], v19 offset:12800
    ds_read_b64_tr_b16 v[156:157], v20 offset:12288
    ds_read_b64_tr_b16 v[158:159], v20 offset:12800
    ds_read_b64_tr_b16 v[160:161], v21 offset:12288
    ds_read_b64_tr_b16 v[162:163], v21 offset:12800
    s_mov_b32 s48, s54
    s_mov_b32 s49, s55
    s_mov_b32 s50, s56
    s_mov_b32 s68, 0
L_vs:
    s_cmp_eq_u32 s26, 0
    s_cbranch_scc1 L_vsl
    s_sub_u32 s26, s26, 1
    s_waitcnt vmcnt(1)
    buffer_load_dwordx4 v[172:175], v2, s[28:31], s69 offen offset:2048 nt
    buffer_load_dwordx4 v[176:179], v2, s[28:31], s69 offen offset:3072 nt
    s_add_u32 s69, s69, 0x8000
    buffer_load_dwordx4 v[180:183], v2, s[28:31], s69 offen offset:0 nt
    v_mov_b32_dpp v38, v83 row_newbcast:0 row_mask:0xf bank_mask:0xf
    v_lshlrev_b32 v84, 16, v164
    v_and_b32 v85, s65, v164
    v_lshlrev_b32 v86, 16, v165
    v_and_b32 v87, s65, v165
    v_lshlrev_b32 v88, 16, v166
    v_and_b32 v89, s65, v166
    v_lshlrev_b32 v90, 16, v167
    v_and_b32 v91, s65, v167
    v_pk_fma_f32 v[44:45], v[84:85], v[38:39], v[44:45] op_sel_hi:[1,0,1]
    v_pk_fma_f32 v[46:47], v[86:87], v[38:39], v[46:47] op_sel_hi:[1,0,1]
    v_pk_fma_f32 v[48:49], v[88:89], v[38:39], v[48:49] op_sel_hi:[1,0,1]
    v_pk_fma_f32 v[50:51], v[90:91], v[38:39], v[50:51] op_sel_hi:[1,0,1]
    s_waitcnt vmcnt(3)
    buffer_load_dwordx4 v[184:187], v2, s[28:31], s69 offen offset:1024 nt
    v_mov_b32_dpp v38, v83 row_newbcast:8 row_mask:0xf bank_mask:0xf
    v_lshlrev_b32 v84, 16, v168
    v_and_b32 v85, s65, v168
    v_lshlrev_b32 v86, 16, v169
    v_and_b32 v87, s65, v169
    v_lshlrev_b32 v88, 16, v170
    v_and_b32 v89, s65, v170
    v_lshlrev_b32 v90, 16, v171
    v_and_b32 v91, s65, v171
    v_pk_fma_f32 v[44:45], v[84:85], v[38:39], v[44:45] op_sel_hi:[1,0,1]
    v_pk_fma_f32 v[46:47], v[86:87], v[38:39], v[46:47] op_sel_hi:[1,0,1]
    v_pk_fma_f32 v[48:49], v[88:89], v[38:39], v[48:49] op_sel_hi:[1,0,1]
    v_pk_fma_f32 v[50:51], v[90:91], v[38:39], v[50:51] op_sel_hi:[1,0,1]
    s_waitcnt vmcnt(3)
    buffer_load_dwordx4 v[188:191], v2, s[28:31], s69 offen offset:2048 nt
    v_mov_b32_dpp v38, v83 row_newbcast:4 row_mask:0xf bank_mask:0xf
    v_lshlrev_b32 v84, 16, v172
    v_and_b32 v85, s65, v172
    v_lshlrev_b32 v86, 16, v173
    v_and_b32 v87, s65, v173
    v_lshlrev_b32 v88, 16, v174
    v_and_b32 v89, s65, v174
    v_lshlrev_b32 v90, 16, v175
    v_and_b32 v91, s65, v175
    v_pk_fma_f32 v[44:45], v[84:85], v[38:39], v[44:45] op_sel_hi:[1,0,1]
    v_pk_fma_f32 v[46:47], v[86:87], v[38:39], v[46:47] op_sel_hi:[1,0,1]
    v_pk_fma_f32 v[48:49], v[88:89], v[38:39], v[48:49] op_sel_hi:[1,0,1]
    v_pk_fma_f32 v[50:51], v[90:91], v[38:39], v[50:51] op_sel_hi:[1,0,1]
    s_waitcnt vmcnt(3)
    buffer_load_dwordx4 v[192:195], v2, s[28:31], s69 offen offset:3072 nt
    v_mov_b32_dpp v38, v83 row_newbcast:12 row_mask:0xf bank_mask:0xf
    v_lshlrev_b32 v84, 16, v176
    v_and_b32 v85, s65, v176
    v_lshlrev_b32 v86, 16, v177
    v_and_b32 v87, s65, v177
    v_lshlrev_b32 v88, 16, v178
    v_and_b32 v89, s65, v178
    v_lshlrev_b32 v90, 16, v179
    v_and_b32 v91, s65, v179
    v_pk_fma_f32 v[44:45], v[84:85], v[38:39], v[44:45] op_sel_hi:[1,0,1]
    v_pk_fma_f32 v[46:47], v[86:87], v[38:39], v[46:47] op_sel_hi:[1,0,1]
    v_pk_fma_f32 v[48:49], v[88:89], v[38:39], v[48:49] op_sel_hi:[1,0,1]
    v_pk_fma_f32 v[50:51], v[90:91], v[38:39], v[50:51] op_sel_hi:[1,0,1]
    s_waitcnt vmcnt(3)
    s_add_u32 s69, s69, 0x8000
    s_cmp_eq_u32 s69, 0x80000
    s_cselect_b32 s28, s48, s28
    s_cselect_b32 s29, s49, s29
    s_cselect_b32 s30, s50, s30
    s_cselect_b32 s69, 0, s69
    buffer_load_dwordx4 v[164:167], v2, s[28:31], s69 offen offset:0 nt
    v_mov_b32_dpp v38, v83 row_newbcast:2 row_mask:0xf bank_mask:0xf
    v_lshlrev_b32 v84, 16, v180
    v_and_b32 v85, s65, v180
    v_lshlrev_b32 v86, 16, v181
    v_and_b32 v87, s65, v181
    v_lshlrev_b32 v88, 16, v182
    v_and_b32 v89, s65, v182
    v_lshlrev_b32 v90, 16, v183
    v_and_b32 v91, s65, v183
    v_pk_fma_f32 v[44:45], v[84:85], v[38:39], v[44:45] op_sel_hi:[1,0,1]
    v_pk_fma_f32 v[46:47], v[86:87], v[38:39], v[46:47] op_sel_hi:[1,0,1]
    v_pk_fma_f32 v[48:49], v[88:89], v[38:39], v[48:49] op_sel_hi:[1,0,1]
    v_pk_fma_f32 v[50:51], v[90:91], v[38:39], v[50:51] op_sel_hi:[1,0,1]
    s_waitcnt vmcnt(7)
    v_perm_b32 v84, v96, v92, s66
    v_perm_b32 v85, v96, v92, s67
    v_perm_b32 v86, v97, v93, s66
    v_perm_b32 v87, v97, v93, s67
    v_perm_b32 v88, v98, v94, s66
    v_perm_b32 v89, v98, v94, s67
    v_perm_b32 v90, v99, v95, s66
    v_perm_b32 v91, v99, v95, s67
    v_dot2c_f32_bf16 v52, v84, v17
    v_dot2c_f32_bf16 v53, v85, v17
    v_dot2c_f32_bf16 v54, v86, v17
    v_dot2c_f32_bf16 v55, v87, v17
    v_dot2c_f32_bf16 v56, v88, v17
    v_dot2c_f32_bf16 v57, v89, v17
    v_dot2c_f32_bf16 v58, v90, v17
    v_dot2c_f32_bf16 v59, v91, v17
    buffer_load_dwordx4 v[92:95], v14, s[32:35], 0 offen nt
    buffer_load_dwordx4 v[96:99], v15, s[32:35], 0 offen nt
    buffer_load_dword v17, v16, s[36:39], 0 offen
    v_add_u32 v14, 0x4000, v14
    v_add_u32 v15, 0x4000, v15
    v_add_u32 v16, 4, v16
    s_waitcnt vmcnt(6)
    buffer_load_dwordx4 v[168:171], v2, s[28:31], s69 offen offset:1024 nt
    v_mov_b32_dpp v38, v83 row_newbcast:10 row_mask:0xf bank_mask:0xf
    v_lshlrev_b32 v84, 16, v184
    v_and_b32 v85, s65, v184
    v_lshlrev_b32 v86, 16, v185
    v_and_b32 v87, s65, v185
    v_lshlrev_b32 v88, 16, v186
    v_and_b32 v89, s65, v186
    v_lshlrev_b32 v90, 16, v187
    v_and_b32 v91, s65, v187
    v_pk_fma_f32 v[44:45], v[84:85], v[38:39], v[44:45] op_sel_hi:[1,0,1]
    v_pk_fma_f32 v[46:47], v[86:87], v[38:39], v[46:47] op_sel_hi:[1,0,1]
    v_pk_fma_f32 v[48:49], v[88:89], v[38:39], v[48:49] op_sel_hi:[1,0,1]
    v_pk_fma_f32 v[50:51], v[90:91], v[38:39], v[50:51] op_sel_hi:[1,0,1]
    s_waitcnt vmcnt(6)
    v_mov_b32_dpp v38, v83 row_newbcast:6 row_mask:0xf bank_mask:0xf
    v_lshlrev_b32 v84, 16, v188
    v_and_b32 v85, s65, v188
    v_lshlrev_b32 v86, 16, v189
    v_and_b32 v87, s65, v189
    v_lshlrev_b32 v88, 16, v190
    v_and_b32 v89, s65, v190
    v_lshlrev_b32 v90, 16, v191
    v_and_b32 v91, s65, v191
    v_pk_fma_f32 v[44:45], v[84:85], v[38:39], v[44:45] op_sel_hi:[1,0,1]
    v_pk_fma_f32 v[46:47], v[86:87], v[38:39], v[46:47] op_sel_hi:[1,0,1]
    v_pk_fma_f32 v[48:49], v[88:89], v[38:39], v[48:49] op_sel_hi:[1,0,1]
    v_pk_fma_f32 v[50:51], v[90:91], v[38:39], v[50:51] op_sel_hi:[1,0,1]
    s_waitcnt vmcnt(5)
    v_mov_b32_dpp v38, v83 row_newbcast:14 row_mask:0xf bank_mask:0xf
    v_lshlrev_b32 v84, 16, v192
    v_and_b32 v85, s65, v192
    v_lshlrev_b32 v86, 16, v193
    v_and_b32 v87, s65, v193
    v_lshlrev_b32 v88, 16, v194
    v_and_b32 v89, s65, v194
    v_lshlrev_b32 v90, 16, v195
    v_and_b32 v91, s65, v195
    v_pk_fma_f32 v[44:45], v[84:85], v[38:39], v[44:45] op_sel_hi:[1,0,1]
    v_pk_fma_f32 v[46:47], v[86:87], v[38:39], v[46:47] op_sel_hi:[1,0,1]
    v_pk_fma_f32 v[48:49], v[88:89], v[38:39], v[48:49] op_sel_hi:[1,0,1]
    v_pk_fma_f32 v[50:51], v[90:91], v[38:39], v[50:51] op_sel_hi:[1,0,1]
    v_mov_b32 v83, v82
    v_mov_b32 v82, v81
    v_mov_b32 v81, v80
    v_mov_b32 v80, v79
    v_mov_b32 v79, v78
    v_mov_b32 v78, v77
    v_mov_b32 v77, v76
    s_add_u32 s68, s68, 1
    s_cmp_lt_u32 s68, 7
    s_cbranch_scc1 L_vs
    s_branch L_burst
L_vsl:
    s_waitcnt vmcnt(1)
    buffer_load_dwordx4 v[172:175], v2, s[28:31], s69 offen offset:2048 nt
    buffer_load_dwordx4 v[176:179], v2, s[28:31], s69 offen offset:3072 nt
    v_mov_b32_dpp v38, v83 row_newbcast:0 row_mask:0xf bank_mask:0xf
    v_lshlrev_b32 v84, 16, v164
    v_and_b32 v85, s65, v164
    v_lshlrev_b32 v86, 16, v165
    v_and_b32 v87, s65, v165
    v_lshlrev_b32 v88, 16, v166
    v_and_b32 v89, s65, v166
    v_lshlrev_b32 v90, 16, v167
    v_and_b32 v91, s65, v167
    v_pk_fma_f32 v[44:45], v[84:85], v[38:39], v[44:45] op_sel_hi:[1,0,1]
    v_pk_fma_f32 v[46:47], v[86:87], v[38:39], v[46:47] op_sel_hi:[1,0,1]
    v_pk_fma_f32 v[48:49], v[88:89], v[38:39], v[48:49] op_sel_hi:[1,0,1]
    v_pk_fma_f32 v[50:51], v[90:91], v[38:39], v[50:51] op_sel_hi:[1,0,1]
    s_waitcnt vmcnt(2)
    s_add_u32 s69, s69, 0x8000
    buffer_load_dwordx4 v[180:183], v2, s[28:31], s69 offen offset:0 nt
    v_mov_b32_dpp v38, v83 row_newbcast:8 row_mask:0xf bank_mask:0xf
    v_lshlrev_b32 v84, 16, v168
    v_and_b32 v85, s65, v168
    v_lshlrev_b32 v86, 16, v169
    v_and_b32 v87, s65, v169
    v_lshlrev_b32 v88, 16, v170
    v_and_b32 v89, s65, v170
    v_lshlrev_b32 v90, 16, v171
    v_and_b32 v91, s65, v171
    v_pk_fma_f32 v[44:45], v[84:85], v[38:39], v[44:45] op_sel_hi:[1,0,1]
    v_pk_fma_f32 v[46:47], v[86:87], v[38:39], v[46:47] op_sel_hi:[1,0,1]
    v_pk_fma_f32 v[48:49], v[88:89], v[38:39], v[48:49] op_sel_hi:[1,0,1]
    v_pk_fma_f32 v[50:51], v[90:91], v[38:39], v[50:51] op_sel_hi:[1,0,1]
    s_waitcnt vmcnt(2)
    buffer_load_dwordx4 v[184:187], v2, s[28:31], s69 offen offset:1024 nt
    v_mov_b32_dpp v38, v83 row_newbcast:4 row_mask:0xf bank_mask:0xf
    v_lshlrev_b32 v84, 16, v172
    v_and_b32 v85, s65, v172
    v_lshlrev_b32 v86, 16, v173
    v_and_b32 v87, s65, v173
    v_lshlrev_b32 v88, 16, v174
    v_and_b32 v89, s65, v174
    v_lshlrev_b32 v90, 16, v175
    v_and_b32 v91, s65, v175
    v_pk_fma_f32 v[44:45], v[84:85], v[38:39], v[44:45] op_sel_hi:[1,0,1]
    v_pk_fma_f32 v[46:47], v[86:87], v[38:39], v[46:47] op_sel_hi:[1,0,1]
    v_pk_fma_f32 v[48:49], v[88:89], v[38:39], v[48:49] op_sel_hi:[1,0,1]
    v_pk_fma_f32 v[50:51], v[90:91], v[38:39], v[50:51] op_sel_hi:[1,0,1]
    s_waitcnt vmcnt(2)
    v_mov_b32_dpp v38, v83 row_newbcast:12 row_mask:0xf bank_mask:0xf
    v_lshlrev_b32 v84, 16, v176
    v_and_b32 v85, s65, v176
    v_lshlrev_b32 v86, 16, v177
    v_and_b32 v87, s65, v177
    v_lshlrev_b32 v88, 16, v178
    v_and_b32 v89, s65, v178
    v_lshlrev_b32 v90, 16, v179
    v_and_b32 v91, s65, v179
    v_pk_fma_f32 v[44:45], v[84:85], v[38:39], v[44:45] op_sel_hi:[1,0,1]
    v_pk_fma_f32 v[46:47], v[86:87], v[38:39], v[46:47] op_sel_hi:[1,0,1]
    v_pk_fma_f32 v[48:49], v[88:89], v[38:39], v[48:49] op_sel_hi:[1,0,1]
    v_pk_fma_f32 v[50:51], v[90:91], v[38:39], v[50:51] op_sel_hi:[1,0,1]
    s_waitcnt vmcnt(1)
    buffer_load_dwordx4 v[188:191], v2, s[28:31], s69 offen offset:2048 nt
    buffer_load_dwordx4 v[192:195], v2, s[28:31], s69 offen offset:3072 nt
    v_mov_b32_dpp v38, v83 row_newbcast:2 row_mask:0xf bank_mask:0xf
    v_lshlrev_b32 v84, 16, v180
    v_and_b32 v85, s65, v180
    v_lshlrev_b32 v86, 16, v181
    v_and_b32 v87, s65, v181
    v_lshlrev_b32 v88, 16, v182
    v_and_b32 v89, s65, v182
    v_lshlrev_b32 v90, 16, v183
    v_and_b32 v91, s65, v183
    v_pk_fma_f32 v[44:45], v[84:85], v[38:39], v[44:45] op_sel_hi:[1,0,1]
    v_pk_fma_f32 v[46:47], v[86:87], v[38:39], v[46:47] op_sel_hi:[1,0,1]
    v_pk_fma_f32 v[48:49], v[88:89], v[38:39], v[48:49] op_sel_hi:[1,0,1]
    v_pk_fma_f32 v[50:51], v[90:91], v[38:39], v[50:51] op_sel_hi:[1,0,1]
    s_waitcnt vmcnt(6)
    v_perm_b32 v84, v96, v92, s66
    v_perm_b32 v85, v96, v92, s67
    v_perm_b32 v86, v97, v93, s66
    v_perm_b32 v87, v97, v93, s67
    v_perm_b32 v88, v98, v94, s66
    v_perm_b32 v89, v98, v94, s67
    v_perm_b32 v90, v99, v95, s66
    v_perm_b32 v91, v99, v95, s67
    v_dot2c_f32_bf16 v52, v84, v17
    v_dot2c_f32_bf16 v53, v85, v17
    v_dot2c_f32_bf16 v54, v86, v17
    v_dot2c_f32_bf16 v55, v87, v17
    v_dot2c_f32_bf16 v56, v88, v17
    v_dot2c_f32_bf16 v57, v89, v17
    v_dot2c_f32_bf16 v58, v90, v17
    v_dot2c_f32_bf16 v59, v91, v17
    buffer_load_dwordx4 v[92:95], v14, s[32:35], 0 offen nt
    buffer_load_dwordx4 v[96:99], v15, s[32:35], 0 offen nt
    buffer_load_dword v17, v16, s[36:39], 0 offen
    v_add_u32 v14, 0x4000, v14
    v_add_u32 v15, 0x4000, v15
    v_add_u32 v16, 4, v16
    s_waitcnt vmcnt(5)
    s_add_u32 s69, s69, 0x8000
    s_cmp_eq_u32 s69, 0x80000
    s_cselect_b32 s28, s48, s28
    s_cselect_b32 s29, s49, s29
    s_cselect_b32 s30, s50, s30
    s_cselect_b32 s69, 0, s69
    buffer_load_dwordx4 v[164:167], v2, s[28:31], s69 offen offset:0 nt
    v_mov_b32_dpp v38, v83 row_newbcast:10 row_mask:0xf bank_mask:0xf
    v_lshlrev_b32 v84, 16, v184
    v_and_b32 v85, s65, v184
    v_lshlrev_b32 v86, 16, v185
    v_and_b32 v87, s65, v185
    v_lshlrev_b32 v88, 16, v186
    v_and_b32 v89, s65, v186
    v_lshlrev_b32 v90, 16, v187
    v_and_b32 v91, s65, v187
    v_pk_fma_f32 v[44:45], v[84:85], v[38:39], v[44:45] op_sel_hi:[1,0,1]
    v_pk_fma_f32 v[46:47], v[86:87], v[38:39], v[46:47] op_sel_hi:[1,0,1]
    v_pk_fma_f32 v[48:49], v[88:89], v[38:39], v[48:49] op_sel_hi:[1,0,1]
    v_pk_fma_f32 v[50:51], v[90:91], v[38:39], v[50:51] op_sel_hi:[1,0,1]
    s_waitcnt vmcnt(5)
    buffer_load_dwordx4 v[168:171], v2, s[28:31], s69 offen offset:1024 nt
    v_mov_b32_dpp v38, v83 row_newbcast:6 row_mask:0xf bank_mask:0xf
    v_lshlrev_b32 v84, 16, v188
    v_and_b32 v85, s65, v188
    v_lshlrev_b32 v86, 16, v189
    v_and_b32 v87, s65, v189
    v_lshlrev_b32 v88, 16, v190
    v_and_b32 v89, s65, v190
    v_lshlrev_b32 v90, 16, v191
    v_and_b32 v91, s65, v191
    v_pk_fma_f32 v[44:45], v[84:85], v[38:39], v[44:45] op_sel_hi:[1,0,1]
    v_pk_fma_f32 v[46:47], v[86:87], v[38:39], v[46:47] op_sel_hi:[1,0,1]
    v_pk_fma_f32 v[48:49], v[88:89], v[38:39], v[48:49] op_sel_hi:[1,0,1]
    v_pk_fma_f32 v[50:51], v[90:91], v[38:39], v[50:51] op_sel_hi:[1,0,1]
    s_waitcnt vmcnt(5)
    v_mov_b32_dpp v38, v83 row_newbcast:14 row_mask:0xf bank_mask:0xf
    v_lshlrev_b32 v84, 16, v192
    v_and_b32 v85, s65, v192
    v_lshlrev_b32 v86, 16, v193
    v_and_b32 v87, s65, v193
    v_lshlrev_b32 v88, 16, v194
    v_and_b32 v89, s65, v194
    v_lshlrev_b32 v90, 16, v195
    v_and_b32 v91, s65, v195
    v_pk_fma_f32 v[44:45], v[84:85], v[38:39], v[44:45] op_sel_hi:[1,0,1]
    v_pk_fma_f32 v[46:47], v[86:87], v[38:39], v[46:47] op_sel_hi:[1,0,1]
    v_pk_fma_f32 v[48:49], v[88:89], v[38:39], v[48:49] op_sel_hi:[1,0,1]
    v_pk_fma_f32 v[50:51], v[90:91], v[38:39], v[50:51] op_sel_hi:[1,0,1]
    v_mov_b32 v83, v82
    v_mov_b32 v82, v81
    v_mov_b32 v81, v80
    v_mov_b32 v80, v79
    v_mov_b32 v79, v78
    v_mov_b32 v78, v77
    v_mov_b32 v77, v76
    s_add_u32 s68, s68, 1
    s_cmp_lt_u32 s68, 7
    s_cbranch_scc1 L_vs
L_burst:
    buffer_load_dwordx4 v[172:175], v2, s[28:31], s69 offen offset:2048 nt
    buffer_load_dwordx4 v[176:179], v2, s[28:31], s69 offen offset:3072 nt
    s_add_u32 s69, s69, 0x8000
    buffer_load_dwordx4 v[180:183], v2, s[28:31], s69 offen offset:0 nt
    buffer_load_dwordx4 v[184:187], v2, s[28:31], s69 offen offset:1024 nt
    buffer_load_dwordx4 v[188:191], v2, s[28:31], s69 offen offset:2048 nt
    buffer_load_dwordx4 v[192:195], v2, s[28:31], s69 offen offset:3072 nt
L_v8:
    s_waitcnt vmcnt(7)
    v_mov_b32_dpp v38, v83 row_newbcast:0 row_mask:0xf bank_mask:0xf
    v_lshlrev_b32 v84, 16, v164
    v_and_b32 v85, s65, v164
    v_lshlrev_b32 v86, 16, v165
    v_and_b32 v87, s65, v165
    v_lshlrev_b32 v88, 16, v166
    v_and_b32 v89, s65, v166
    v_lshlrev_b32 v90, 16, v167
    v_and_b32 v91, s65, v167
    s_add_u32 s69, s69, 0x8000
    s_cmp_eq_u32 s69, 0x80000
    s_cselect_b32 s28, s48, s28
    s_cselect_b32 s29, s49, s29
    s_cselect_b32 s30, s50, s30
    s_cselect_b32 s69, 0, s69
    buffer_load_dwordx4 v[164:167], v2, s[28:31], s69 offen offset:0 nt
    v_pk_fma_f32 v[44:45], v[84:85], v[38:39], v[44:45] op_sel_hi:[1,0,1]
    v_pk_fma_f32 v[46:47], v[86:87], v[38:39], v[46:47] op_sel_hi:[1,0,1]
    v_pk_fma_f32 v[48:49], v[88:89], v[38:39], v[48:49] op_sel_hi:[1,0,1]
    v_pk_fma_f32 v[50:51], v[90:91], v[38:39], v[50:51] op_sel_hi:[1,0,1]
    s_waitcnt vmcnt(7)
    v_mov_b32_dpp v38, v83 row_newbcast:8 row_mask:0xf bank_mask:0xf
    v_lshlrev_b32 v84, 16, v168
    v_and_b32 v85, s65, v168
    v_lshlrev_b32 v86, 16, v169
    v_and_b32 v87, s65, v169
    v_lshlrev_b32 v88, 16, v170
    v_and_b32 v89, s65, v170
    v_lshlrev_b32 v90, 16, v171
    v_and_b32 v91, s65, v171
    buffer_load_dwordx4 v[168:171], v2, s[28:31], s69 offen offset:1024 nt
    v_pk_fma_f32 v[44:45], v[84:85], v[38:39], v[44:45] op_sel_hi:[1,0,1]
    v_pk_fma_f32 v[46:47], v[86:87], v[38:39], v[46:47] op_sel_hi:[1,0,1]
    v_pk_fma_f32 v[48:49], v[88:89], v[38:39], v[48:49] op_sel_hi:[1,0,1]
    v_pk_fma_f32 v[50:51], v[90:91], v[38:39], v[50:51] op_sel_hi:[1,0,1]
    s_waitcnt vmcnt(7)
    v_mov_b32_dpp v38, v83 row_newbcast:4 row_mask:0xf bank_mask:0xf
    v_lshlrev_b32 v84, 16, v172
    v_and_b32 v85, s65, v172
    v_lshlrev_b32 v86, 16, v173
    v_and_b32 v87, s65, v173
    v_lshlrev_b32 v88, 16, v174
    v_and_b32 v89, s65, v174
    v_lshlrev_b32 v90, 16, v175
    v_and_b32 v91, s65, v175
    buffer_load_dwordx4 v[172:175], v2, s[28:31], s69 offen offset:2048 nt
    v_pk_fma_f32 v[44:45], v[84:85], v[38:39], v[44:45] op_sel_hi:[1,0,1]
    v_pk_fma_f32 v[46:47], v[86:87], v[38:39], v[46:47] op_sel_hi:[1,0,1]
    v_pk_fma_f32 v[48:49], v[88:89], v[38:39], v[48:49] op_sel_hi:[1,0,1]
    v_pk_fma_f32 v[50:51], v[90:91], v[38:39], v[50:51] op_sel_hi:[1,0,1]
    s_waitcnt vmcnt(7)
    v_mov_b32_dpp v38, v83 row_newbcast:12 row_mask:0xf bank_mask:0xf
    v_lshlrev_b32 v84, 16, v176
    v_and_b32 v85, s65, v176
    v_lshlrev_b32 v86, 16, v177
    v_and_b32 v87, s65, v177
    v_lshlrev_b32 v88, 16, v178
    v_and_b32 v89, s65, v178
    v_lshlrev_b32 v90, 16, v179
    v_and_b32 v91, s65, v179
    buffer_load_dwordx4 v[176:179], v2, s[28:31], s69 offen offset:3072 nt
    v_pk_fma_f32 v[44:45], v[84:85], v[38:39], v[44:45] op_sel_hi:[1,0,1]
    v_pk_fma_f32 v[46:47], v[86:87], v[38:39], v[46:47] op_sel_hi:[1,0,1]
    v_pk_fma_f32 v[48:49], v[88:89], v[38:39], v[48:49] op_sel_hi:[1,0,1]
    v_pk_fma_f32 v[50:51], v[90:91], v[38:39], v[50:51] op_sel_hi:[1,0,1]
    s_waitcnt vmcnt(7)
    v_mov_b32_dpp v38, v83 row_newbcast:2 row_mask:0xf bank_mask:0xf
    v_lshlrev_b32 v84, 16, v180
    v_and_b32 v85, s65, v180
    v_lshlrev_b32 v86, 16, v181
    v_and_b32 v87, s65, v181
    v_lshlrev_b32 v88, 16, v182
    v_and_b32 v89, s65, v182
    v_lshlrev_b32 v90, 16, v183
    v_and_b32 v91, s65, v183
    s_add_u32 s69, s69, 0x8000
    buffer_load_dwordx4 v[180:183], v2, s[28:31], s69 offen offset:0 nt
    v_pk_fma_f32 v[44:45], v[84:85], v[38:39], v[44:45] op_sel_hi:[1,0,1]
    v_pk_fma_f32 v[46:47], v[86:87], v[38:39], v[46:47] op_sel_hi:[1,0,1]
    v_pk_fma_f32 v[48:49], v[88:89], v[38:39], v[48:49] op_sel_hi:[1,0,1]
    v_pk_fma_f32 v[50:51], v[90:91], v[38:39], v[50:51] op_sel_hi:[1,0,1]
    s_waitcnt vmcnt(12)
    v_perm_b32 v84, v96, v92, s66
    v_perm_b32 v85, v96, v92, s67
    v_perm_b32 v86, v97, v93, s66
    v_perm_b32 v87, v97, v93, s67
    v_perm_b32 v88, v98, v94, s66
    v_perm_b32 v89, v98, v94, s67
    v_perm_b32 v90, v99, v95, s66
    v_perm_b32 v91, v99, v95, s67
    v_dot2c_f32_bf16 v52, v84, v17
    v_dot2c_f32_bf16 v53, v85, v17
    v_dot2c_f32_bf16 v54, v86, v17
    v_dot2c_f32_bf16 v55, v87, v17
    v_dot2c_f32_bf16 v56, v88, v17
    v_dot2c_f32_bf16 v57, v89, v17
    v_dot2c_f32_bf16 v58, v90, v17
    v_dot2c_f32_bf16 v59, v91, v17
    s_waitcnt vmcnt(7)
    v_mov_b32_dpp v38, v83 row_newbcast:10 row_mask:0xf bank_mask:0xf
    v_lshlrev_b32 v84, 16, v184
    v_and_b32 v85, s65, v184
    v_lshlrev_b32 v86, 16, v185
    v_and_b32 v87, s65, v185
    v_lshlrev_b32 v88, 16, v186
    v_and_b32 v89, s65, v186
    v_lshlrev_b32 v90, 16, v187
    v_and_b32 v91, s65, v187
    buffer_load_dwordx4 v[184:187], v2, s[28:31], s69 offen offset:1024 nt
    v_pk_fma_f32 v[44:45], v[84:85], v[38:39], v[44:45] op_sel_hi:[1,0,1]
    v_pk_fma_f32 v[46:47], v[86:87], v[38:39], v[46:47] op_sel_hi:[1,0,1]
    v_pk_fma_f32 v[48:49], v[88:89], v[38:39], v[48:49] op_sel_hi:[1,0,1]
    v_pk_fma_f32 v[50:51], v[90:91], v[38:39], v[50:51] op_sel_hi:[1,0,1]
    s_waitcnt vmcnt(7)
    v_mov_b32_dpp v38, v83 row_newbcast:6 row_mask:0xf bank_mask:0xf
    v_lshlrev_b32 v84, 16, v188
    v_and_b32 v85, s65, v188
    v_lshlrev_b32 v86, 16, v189
    v_and_b32 v87, s65, v189
    v_lshlrev_b32 v88, 16, v190
    v_and_b32 v89, s65, v190
    v_lshlrev_b32 v90, 16, v191
    v_and_b32 v91, s65, v191
    buffer_load_dwordx4 v[188:191], v2, s[28:31], s69 offen offset:2048 nt
    v_pk_fma_f32 v[44:45], v[84:85], v[38:39], v[44:45] op_sel_hi:[1,0,1]
    v_pk_fma_f32 v[46:47], v[86:87], v[38:39], v[46:47] op_sel_hi:[1,0,1]
    v_pk_fma_f32 v[48:49], v[88:89], v[38:39], v[48:49] op_sel_hi:[1,0,1]
    v_pk_fma_f32 v[50:51], v[90:91], v[38:39], v[50:51] op_sel_hi:[1,0,1]
    s_waitcnt vmcnt(7)
    v_mov_b32_dpp v38, v83 row_newbcast:14 row_mask:0xf bank_mask:0xf
    v_lshlrev_b32 v84, 16, v192
    v_and_b32 v85, s65, v192
    v_lshlrev_b32 v86, 16, v193
    v_and_b32 v87, s65, v193
    v_lshlrev_b32 v88, 16, v194
    v_and_b32 v89, s65, v194
    v_lshlrev_b32 v90, 16, v195
    v_and_b32 v91, s65, v195
    buffer_load_dwordx4 v[192:195], v2, s[28:31], s69 offen offset:3072 nt
    v_pk_fma_f32 v[44:45], v[84:85], v[38:39], v[44:45] op_sel_hi:[1,0,1]
    v_pk_fma_f32 v[46:47], v[86:87], v[38:39], v[46:47] op_sel_hi:[1,0,1]
    v_pk_fma_f32 v[48:49], v[88:89], v[38:39], v[48:49] op_sel_hi:[1,0,1]
    v_pk_fma_f32 v[50:51], v[90:91], v[38:39], v[50:51] op_sel_hi:[1,0,1]
    v_mov_b32 v83, v82
    v_mov_b32 v82, v81
    v_mov_b32 v81, v80
    v_mov_b32 v80, v79
    v_mov_b32 v79, v78
    v_mov_b32 v78, v77
    v_mov_b32 v77, v76
    s_add_u32 s68, s68, 1
    s_cmp_lt_u32 s68, 8
    s_cbranch_scc1 L_v8
    v_permlane32_swap_b32 v44, v48
    v_permlane32_swap_b32 v46, v50
    v_permlane32_swap_b32 v45, v49
    v_permlane32_swap_b32 v47, v51
    v_add_f32 v44, v44, v48
    v_add_f32 v46, v46, v50
    v_add_f32 v45, v45, v49
    v_add_f32 v47, v47, v51
    v_permlane16_swap_b32 v44, v46
    s_nop 0
    v_permlane16_swap_b32 v45, v47
    v_add_f32 v84, v44, v46
    v_add_f32 v85, v45, v47
    v_cvt_pk_bf16_f32 v86, v84, v85
    ds_write_b32 v24, v86
    v_lshlrev_b32 v88, 16, v86
    v_and_b32 v89, s65, v86
    v_sub_f32 v88, v84, v88
    v_sub_f32 v89, v85, v89
    v_cvt_pk_bf16_f32 v87, v88, v89
    ds_write_b32 v24, v87 offset:2176
    s_cmp_lg_u32 s73, 0
    s_cbranch_scc1 L_noq1
    v_permlane32_swap_b32 v52, v56
    v_permlane32_swap_b32 v54, v58
    v_permlane32_swap_b32 v53, v57
    v_permlane32_swap_b32 v55, v59
    v_add_f32 v52, v52, v56
    v_add_f32 v54, v54, v58
    v_add_f32 v53, v53, v57
    v_add_f32 v55, v55, v59
    v_permlane16_swap_b32 v52, v54
    s_nop 0
    v_permlane16_swap_b32 v53, v55
    v_add_f32 v90, v52, v54
    v_add_f32 v91, v53, v55
    ds_write_b64 v22, v[90:91]
    s_branch L_noq2
L_noq1:
    s_sub_u32 s60, s76, 0x80000
    buffer_store_dword v36, v29, s[44:47], s60 offen
L_noq2:
    s_waitcnt lgkmcnt(0)
    s_barrier
    ds_read_b128 v[196:199], v25 offset:0
    ds_read_b128 v[200:203], v25 offset:64
    ds_read_b128 v[204:207], v25 offset:128
    ds_read_b128 v[208:211], v25 offset:192
    ds_read_b128 v[212:215], v26
    ds_read_b128 v[216:219], v26 offset:16
    ds_read_b128 v[220:223], v27
    ds_read_b128 v[224:227], v27 offset:16
    s_waitcnt lgkmcnt(7)
    v_mfma_f32_16x16x32_bf16 v[228:231], v[196:199], v[100:103], 0
    v_mfma_f32_16x16x32_bf16 v[232:235], v[196:199], v[104:107], 0
    v_mfma_f32_16x16x32_bf16 v[236:239], v[196:199], v[108:111], 0
    v_mfma_f32_16x16x32_bf16 v[240:243], v[196:199], v[112:115], 0
    s_waitcnt lgkmcnt(6)
    v_mfma_f32_16x16x32_bf16 v[228:231], v[200:203], v[116:119], v[228:231]
    v_mfma_f32_16x16x32_bf16 v[232:235], v[200:203], v[120:123], v[232:235]
    v_mfma_f32_16x16x32_bf16 v[236:239], v[200:203], v[124:127], v[236:239]
    v_mfma_f32_16x16x32_bf16 v[240:243], v[200:203], v[128:131], v[240:243]
    s_waitcnt lgkmcnt(5)
    v_mfma_f32_16x16x32_bf16 v[228:231], v[204:207], v[132:135], v[228:231]
    v_mfma_f32_16x16x32_bf16 v[232:235], v[204:207], v[136:139], v[232:235]
    v_mfma_f32_16x16x32_bf16 v[236:239], v[204:207], v[140:143], v[236:239]
    v_mfma_f32_16x16x32_bf16 v[240:243], v[204:207], v[144:147], v[240:243]
    s_waitcnt lgkmcnt(4)
    v_mfma_f32_16x16x32_bf16 v[228:231], v[208:211], v[148:151], v[228:231]
    v_mfma_f32_16x16x32_bf16 v[232:235], v[208:211], v[152:155], v[232:235]
    v_mfma_f32_16x16x32_bf16 v[236:239], v[208:211], v[156:159], v[236:239]
    v_mfma_f32_16x16x32_bf16 v[240:243], v[208:211], v[160:163], v[240:243]
    s_waitcnt lgkmcnt(0)
    v_max3_f32 v3, v212, v214, v216
    v_max3_f32 v3, v218, v220, v3
    v_max3_f32 v3, v222, v224, v3
    v_max_f32 v10, v226, v3
    v_sub_f32 v244, v212, v10
    v_sub_f32 v245, v214, v10
    v_sub_f32 v246, v216, v10
    v_sub_f32 v247, v218, v10
    v_sub_f32 v248, v220, v10
    v_sub_f32 v249, v222, v10
    v_sub_f32 v250, v224, v10
    v_sub_f32 v251, v226, v10
    v_exp_f32 v244, v244
    v_exp_f32 v245, v245
    v_exp_f32 v246, v246
    v_exp_f32 v247, v247
    v_exp_f32 v248, v248
    v_exp_f32 v249, v249
    v_exp_f32 v250, v250
    v_exp_f32 v251, v251
    v_mul_f32 v84, v244, v228
    v_mul_f32 v85, v244, v232
    v_mul_f32 v86, v244, v236
    v_mul_f32 v87, v244, v240
    v_fmac_f32 v84, v245, v229
    v_fmac_f32 v85, v245, v233
    v_fmac_f32 v86, v245, v237
    v_fmac_f32 v87, v245, v241
    v_fmac_f32 v84, v246, v230
    v_fmac_f32 v85, v246, v234
    v_fmac_f32 v86, v246, v238
    v_fmac_f32 v87, v246, v242
    v_fmac_f32 v84, v247, v231
    v_fmac_f32 v85, v247, v235
    v_fmac_f32 v86, v247, v239
    v_fmac_f32 v87, v247, v243
    v_mul_f32 v11, v244, v213
    v_permlane32_swap_b32 v84, v86
    v_permlane32_swap_b32 v85, v87
    v_fmac_f32 v11, v245, v215
    v_add_f32 v84, v84, v86
    v_add_f32 v85, v85, v87
    v_fmac_f32 v11, v246, v217
    v_fmac_f32 v11, v247, v219
    v_permlane16_swap_b32 v84, v85
    v_add_f32 v84, v84, v85
    s_cmp_lg_u32 s73, 0
    s_cbranch_scc0 L_keep
    buffer_store_dword v84, v29, s[44:47], s76 offen
    s_cmp_lg_u32 s3, 0
    s_cbranch_scc1 L_fin
    v_fmac_f32 v11, v248, v221
    v_fmac_f32 v11, v249, v223
    v_fmac_f32 v11, v250, v225
    v_fmac_f32 v11, v251, v227
    s_mov_b64 exec, 0xff
    buffer_store_dwordx4 v[8:11], v37, s[44:47], s77 offen
    s_branch L_fin
L_keep:
    s_nop 0
    v_fmac_f32 v11, v248, v221
    v_fmac_f32 v11, v249, v223
    v_fmac_f32 v11, v250, v225
    v_fmac_f32 v11, v251, v227
    v_mov_b32 v36, v84
    v_mov_b32 v8, v10
    v_mov_b32 v9, v11
    ds_read_b64 v[60:61], v23 offset:0
    ds_read_b64 v[62:63], v23 offset:512
    ds_read_b64 v[64:65], v23 offset:1024
    ds_read_b64 v[66:67], v23 offset:1536
    ds_read_b64 v[68:69], v23 offset:2048
    ds_read_b64 v[70:71], v23 offset:2560
    ds_read_b64 v[72:73], v23 offset:3072
    ds_read_b64 v[74:75], v23 offset:3584
    s_mov_b32 s73, 1
    s_mov_b32 s68, 0
    s_mov_b32 s48, s58
    s_mov_b32 s49, s59
    s_mov_b32 s56, 0
    s_mov_b32 s34, 0
    s_mov_b32 s38, 0
    s_mov_b32 s40, s22
    s_mov_b32 s41, s23
    s_mov_b32 s74, 0
    s_lshl_b32 s75, s3, 14
    s_add_u32 s76, s76, 0x80000
    v_add_u32 v24, 0x1100, v24
    v_add_u32 v25, 0x1100, v25
    v_add_u32 v28, 64, v28
    v_add_u32 v26, 64, v26
    v_add_u32 v27, 64, v27
    s_waitcnt lgkmcnt(0)
    v_add_f32 v60, v60, v62
    v_add_f32 v61, v61, v63
    v_add_f32 v60, v60, v64
    v_add_f32 v61, v61, v65
    v_add_f32 v60, v60, v66
    v_add_f32 v61, v61, v67
    v_add_f32 v60, v60, v68
    v_add_f32 v61, v61, v69
    v_add_f32 v60, v60, v70
    v_add_f32 v61, v61, v71
    v_add_f32 v60, v60, v72
    v_add_f32 v61, v61, v73
    v_add_f32 v60, v60, v74
    v_add_f32 v61, v61, v75
    v_cvt_pk_bf16_f32 v40, v60, v61
    v_mov_b32 v41, v40
    s_nop 1
    v_permlane16_swap_b32 v40, v41
    v_mov_b32 v42, v40
    v_mov_b32 v43, v41
    s_nop 0
    v_permlane32_swap_b32 v40, v42
    v_permlane32_swap_b32 v41, v43
    s_nop 1
    s_branch L_prob
L_fin:
L_attn_end:
    s_endpgm
.globl reduce_kernel
.p2align 8
.type reduce_kernel,@function
reduce_kernel:
    s_load_dwordx2 s[6:7], s[0:1], 96
    s_load_dwordx2 s[4:5], s[0:1], 80
    s_cmp_ge_u32 s2, 64
    s_cbranch_scc1 L_red_end
    v_lshrrev_b32 v2, 6, v0
    v_and_b32 v0, 63, v0
    v_readfirstlane_b32 s3, v2
    s_mul_i32 s2, s2, 2
    s_add_u32 s2, s2, s3
    s_lshr_b32 s3, s2, 2
    s_lshl_b32 s16, s3, 15
    s_and_b32 s17, s2, 3
    s_lshl_b32 s18, s17, 6
    s_add_u32 s16, s16, s18
    s_add_u32 s18, s16, 0x4000
    v_lshrrev_b32 v2, 2, v0
    v_and_b32 v3, 3, v0
    v_lshlrev_b32 v3, 4, v3
    v_lshl_add_u32 v1, v2, 10, v3
    v_lshlrev_b32 v4, 7, v0
    s_bfe_u32 s19, s2, 0x10005
    s_lshl_b32 s20, s19, 14
    s_lshr_b32 s21, s2, 6
    s_lshl_b32 s22, s21, 3
    s_add_u32 s20, s20, s22
    s_add_u32 s20, s20, 0x100000
    s_add_u32 s22, s20, 0x2000
    s_mov_b32 s10, 0x108000
    s_mov_b32 s11, 0x00020000
    s_mov_b32 s14, 4096
    s_mov_b32 s15, 0x00020000
    s_waitcnt lgkmcnt(0)
    s_mov_b32 s8, s6
    s_mov_b32 s9, s7
    buffer_load_dwordx2 v[8:9], v4, s[8:11], s20 offen
    buffer_load_dwordx2 v[10:11], v4, s[8:11], s22 offen
    buffer_load_dwordx4 v[16:19], v1, s[8:11], s16 offen offset:0
    buffer_load_dwordx4 v[20:23], v1, s[8:11], s16 offen offset:256
    buffer_load_dwordx4 v[24:27], v1, s[8:11], s16 offen offset:512
    buffer_load_dwordx4 v[28:31], v1, s[8:11], s16 offen offset:768
    buffer_load_dwordx4 v[32:35], v1, s[8:11], s18 offen offset:0
    buffer_load_dwordx4 v[36:39], v1, s[8:11], s18 offen offset:256
    buffer_load_dwordx4 v[40:43], v1, s[8:11], s18 offen offset:512
    buffer_load_dwordx4 v[44:47], v1, s[8:11], s18 offen offset:768
    s_mov_b32 s12, s4
    s_mov_b32 s13, s5
    s_lshl_b32 s19, s19, 11
    s_lshl_b32 s21, s21, 10
    s_add_u32 s19, s19, s21
    s_and_b32 s21, s2, 31
    s_lshl_b32 s21, s21, 5
    s_add_u32 s19, s19, s21
    v_lshrrev_b32 v2, 4, v0
    v_lshrrev_b32 v3, 1, v3
    v_lshl_add_u32 v5, v2, 1, v3
    s_mov_b32 s26, 0x000f000f
    s_mov_b32 s27, 0x000f000f
    s_waitcnt vmcnt(8)
    v_max_f32_dpp v2, v8, v8 quad_perm:[1,0,3,2] row_mask:0xf bank_mask:0xf
    v_max_f32_dpp v3, v10, v10 quad_perm:[1,0,3,2] row_mask:0xf bank_mask:0xf
    s_nop 0
    v_max_f32_dpp v2, v2, v2 quad_perm:[2,3,0,1] row_mask:0xf bank_mask:0xf
    v_max_f32_dpp v3, v3, v3 quad_perm:[2,3,0,1] row_mask:0xf bank_mask:0xf
    v_sub_f32 v6, v8, v2
    v_sub_f32 v7, v10, v3
    v_exp_f32 v6, v6
    v_exp_f32 v7, v7
    v_mul_f32 v2, v6, v9
    v_mul_f32 v3, v7, v11
    s_nop 0
    v_add_f32_dpp v2, v2, v2 quad_perm:[1,0,3,2] row_mask:0xf bank_mask:0xf
    v_add_f32_dpp v3, v3, v3 quad_perm:[1,0,3,2] row_mask:0xf bank_mask:0xf
    s_nop 0
    v_add_f32_dpp v2, v2, v2 quad_perm:[2,3,0,1] row_mask:0xf bank_mask:0xf
    v_add_f32_dpp v3, v3, v3 quad_perm:[2,3,0,1] row_mask:0xf bank_mask:0xf
    v_rcp_f32 v2, v2
    v_rcp_f32 v3, v3
    v_mul_f32 v6, v6, v2
    v_mul_f32 v7, v7, v3
    s_waitcnt vmcnt(7)
    v_mul_f32_dpp v12, v6, v16 quad_perm:[0,0,0,0] row_mask:0xf bank_mask:0xf
    v_mul_f32_dpp v13, v6, v17 quad_perm:[0,0,0,0] row_mask:0xf bank_mask:0xf
    v_mul_f32_dpp v14, v6, v18 quad_perm:[0,0,0,0] row_mask:0xf bank_mask:0xf
    v_mul_f32_dpp v15, v6, v19 quad_perm:[0,0,0,0] row_mask:0xf bank_mask:0xf
    s_waitcnt vmcnt(6)
    v_fmac_f32_dpp v12, v6, v20 quad_perm:[1,1,1,1] row_mask:0xf bank_mask:0xf
    v_fmac_f32_dpp v13, v6, v21 quad_perm:[1,1,1,1] row_mask:0xf bank_mask:0xf
    v_fmac_f32_dpp v14, v6, v22 quad_perm:[1,1,1,1] row_mask:0xf bank_mask:0xf
    v_fmac_f32_dpp v15, v6, v23 quad_perm:[1,1,1,1] row_mask:0xf bank_mask:0xf
    s_waitcnt vmcnt(5)
    v_fmac_f32_dpp v12, v6, v24 quad_perm:[2,2,2,2] row_mask:0xf bank_mask:0xf
    v_fmac_f32_dpp v13, v6, v25 quad_perm:[2,2,2,2] row_mask:0xf bank_mask:0xf
    v_fmac_f32_dpp v14, v6, v26 quad_perm:[2,2,2,2] row_mask:0xf bank_mask:0xf
    v_fmac_f32_dpp v15, v6, v27 quad_perm:[2,2,2,2] row_mask:0xf bank_mask:0xf
    s_waitcnt vmcnt(4)
    v_fmac_f32_dpp v12, v6, v28 quad_perm:[3,3,3,3] row_mask:0xf bank_mask:0xf
    v_fmac_f32_dpp v13, v6, v29 quad_perm:[3,3,3,3] row_mask:0xf bank_mask:0xf
    v_fmac_f32_dpp v14, v6, v30 quad_perm:[3,3,3,3] row_mask:0xf bank_mask:0xf
    v_fmac_f32_dpp v15, v6, v31 quad_perm:[3,3,3,3] row_mask:0xf bank_mask:0xf
    s_waitcnt vmcnt(3)
    v_fmac_f32_dpp v12, v7, v32 quad_perm:[0,0,0,0] row_mask:0xf bank_mask:0xf
    v_fmac_f32_dpp v13, v7, v33 quad_perm:[0,0,0,0] row_mask:0xf bank_mask:0xf
    v_fmac_f32_dpp v14, v7, v34 quad_perm:[0,0,0,0] row_mask:0xf bank_mask:0xf
    v_fmac_f32_dpp v15, v7, v35 quad_perm:[0,0,0,0] row_mask:0xf bank_mask:0xf
    s_waitcnt vmcnt(2)
    v_fmac_f32_dpp v12, v7, v36 quad_perm:[1,1,1,1] row_mask:0xf bank_mask:0xf
    v_fmac_f32_dpp v13, v7, v37 quad_perm:[1,1,1,1] row_mask:0xf bank_mask:0xf
    v_fmac_f32_dpp v14, v7, v38 quad_perm:[1,1,1,1] row_mask:0xf bank_mask:0xf
    v_fmac_f32_dpp v15, v7, v39 quad_perm:[1,1,1,1] row_mask:0xf bank_mask:0xf
    s_waitcnt vmcnt(1)
    v_fmac_f32_dpp v12, v7, v40 quad_perm:[2,2,2,2] row_mask:0xf bank_mask:0xf
    v_fmac_f32_dpp v13, v7, v41 quad_perm:[2,2,2,2] row_mask:0xf bank_mask:0xf
    v_fmac_f32_dpp v14, v7, v42 quad_perm:[2,2,2,2] row_mask:0xf bank_mask:0xf
    v_fmac_f32_dpp v15, v7, v43 quad_perm:[2,2,2,2] row_mask:0xf bank_mask:0xf
    s_waitcnt vmcnt(0)
    v_fmac_f32_dpp v12, v7, v44 quad_perm:[3,3,3,3] row_mask:0xf bank_mask:0xf
    v_fmac_f32_dpp v13, v7, v45 quad_perm:[3,3,3,3] row_mask:0xf bank_mask:0xf
    v_fmac_f32_dpp v14, v7, v46 quad_perm:[3,3,3,3] row_mask:0xf bank_mask:0xf
    v_fmac_f32_dpp v15, v7, v47 quad_perm:[3,3,3,3] row_mask:0xf bank_mask:0xf
    v_add_f32_dpp v12, v12, v12 row_ror:8 row_mask:0xf bank_mask:0xf
    v_add_f32_dpp v13, v13, v13 row_ror:8 row_mask:0xf bank_mask:0xf
    v_add_f32_dpp v14, v14, v14 row_ror:8 row_mask:0xf bank_mask:0xf
    v_add_f32_dpp v15, v15, v15 row_ror:8 row_mask:0xf bank_mask:0xf
    v_add_f32_dpp v12, v12, v12 row_ror:4 row_mask:0xf bank_mask:0xf
    v_add_f32_dpp v13, v13, v13 row_ror:4 row_mask:0xf bank_mask:0xf
    v_add_f32_dpp v14, v14, v14 row_ror:4 row_mask:0xf bank_mask:0xf
    v_add_f32_dpp v15, v15, v15 row_ror:4 row_mask:0xf bank_mask:0xf
    s_nop 0
    v_permlane32_swap_b32 v12, v14
    v_permlane32_swap_b32 v13, v15
    v_add_f32 v12, v12, v14
    v_add_f32 v13, v13, v15
    s_nop 1
    v_permlane16_swap_b32 v12, v13
    v_add_f32 v12, v12, v13
    v_cvt_pk_bf16_f32 v12, v12, v12
    s_mov_b64 exec, s[26:27]
    buffer_store_short v12, v5, s[12:15], s19 offen
L_red_end:
    s_endpgm
.section .rodata,"a"
.p2align 6
.amdhsa_kernel concat_heads__mha_block_cached__mha_block_cached__decode_kernel
  .amdhsa_next_free_vgpr 252
  .amdhsa_next_free_sgpr 84
  .amdhsa_accum_offset 252
  .amdhsa_group_segment_fixed_size 0
  .amdhsa_kernarg_size 104
  .amdhsa_user_sgpr_count 2
  .amdhsa_user_sgpr_kernarg_segment_ptr 1
  .amdhsa_system_sgpr_workgroup_id_x 1
.end_amdhsa_kernel
.p2align 6
.amdhsa_kernel reduce_kernel
  .amdhsa_next_free_vgpr 48
  .amdhsa_next_free_sgpr 32
  .amdhsa_accum_offset 48
  .amdhsa_group_segment_fixed_size 0
  .amdhsa_kernarg_size 104
  .amdhsa_user_sgpr_count 2
  .amdhsa_user_sgpr_kernarg_segment_ptr 1
  .amdhsa_system_sgpr_workgroup_id_x 1
.end_amdhsa_kernel
```
